```python
import torch

def _softmax(x, axis=-1):
    return torch.softmax(x, dim=axis)
def _gelu(x):
    return torch.nn.functional.gelu(x, approximate="tanh")
def _silu(x):
    return torch.nn.functional.silu(x)
def _sigmoid(x):
    return torch.sigmoid(x)
def _layernorm(x, axis=-1, eps=1e-5):
    m = x.mean(dim=axis, keepdim=True)
    v = x.var(dim=axis, keepdim=True, unbiased=False)
    return (x - m) / torch.sqrt(v + eps)
def _scatter_add(tgt, idx, src, axis=0):
    return tgt.clone().index_add_(axis, idx, src)
def _segment_sum(src, seg, n):
    out = torch.zeros((n,) + src.shape[1:], dtype=src.dtype)
    return out.index_add_(0, seg, src)
def _pad(x, pw):
    flat = tuple(v for pair in reversed(pw) for v in pair)
    return torch.nn.functional.pad(x, flat)

kernel_name = 'standalone__kv_cache_quant_int4_int2_kv_with_per_channel_or_per_token_scales__prompt'

def setup_inputs():

    _w = (lambda a: (lambda t: t.to(torch.bfloat16) if t.is_floating_point() else t)(torch.as_tensor(a)))
    B = 1
    Sq = 2048
    Skv = 2048
    Hq = 32
    Hkv = 4
    Dh = 128
    bits = 3
    G = -1
    if G <= 0 or G >= Skv:
        G = max(1, Skv // 2)
    Skv = (Skv // G) * G
    ngk = Skv // G
    qmax = (1 << bits) - 1
    return {
        "q": _w((lambda *s: torch.randn(*s, dtype=torch.bfloat16) * 1.6)(B, Hq, Sq, Dh)),
        "qk": _w(torch.randint(0, qmax + 1, (B, Hkv, Skv, Dh)).to(torch.int32)),
        "qv": _w(torch.randint(0, qmax + 1, (B, Hkv, Skv, Dh)).to(torch.int32)),
        "k_scales": _w(torch.abs((lambda *s: torch.randn(*s, dtype=torch.bfloat16) * 1.6)(B, Hkv, ngk, Dh)) * 0.05 + 0.02),
        "k_zeros": _w((lambda *s: torch.randn(*s, dtype=torch.bfloat16) * 1.6)(B, Hkv, ngk, Dh) + float(qmax) / 2.0),
        "v_scales": _w(torch.abs((lambda *s: torch.randn(*s, dtype=torch.bfloat16) * 0.05)(B, Hkv, Skv, 1)) * 0.05 + 0.02),
        "v_zeros": _w((lambda *s: torch.randn(*s, dtype=torch.bfloat16) * 0.05)(B, Hkv, Skv, 1) + float(qmax) / 2.0),
    }

def reference(q, qk, qv, k_scales, k_zeros, v_scales, v_zeros):
    B, Hq, Sq, Dh = q.shape
    Hkv, Skv = qk.shape[1], qk.shape[2]
    ngk = k_scales.shape[2]
    G = Skv // ngk
    ks = (lambda x, n, axis: torch.repeat_interleave(x, n, dim=axis))(k_scales, G, axis=2)
    kz = (lambda x, n, axis: torch.repeat_interleave(x, n, dim=axis))(k_zeros, G, axis=2)
    k = ((lambda x, dt: x.to(dt))(qk, q.dtype) - kz) * ks
    v = ((lambda x, dt: x.to(dt))(qv, q.dtype) - v_zeros) * v_scales
    rep = Hq // Hkv
    if rep > 1:
        k = (lambda x, n, axis: torch.repeat_interleave(x, n, dim=axis))(k, rep, axis=1)
        v = (lambda x, n, axis: torch.repeat_interleave(x, n, dim=axis))(v, rep, axis=1)
    scale = float(Dh) ** -0.5
    logits = torch.einsum("bhqd,bhkd->bhqk", q, k) * scale
    p = _softmax(logits, axis=-1)
    o = torch.einsum("bhqk,bhkd->bhqd", p, v)
    return o
```

```asm
; @launch grid=(256,1,1) block=(256,1,1) lds=163840
.amdgcn_target "amdgcn-amd-amdhsa--gfx950"
.text
.globl standalone__kv_cache_quant_int4_int2_kv_with_per_channel_or_per_token_scales__prompt_kernel
.p2align 8
.type standalone__kv_cache_quant_int4_int2_kv_with_per_channel_or_per_token_scales__prompt_kernel,@function
standalone__kv_cache_quant_int4_int2_kv_with_per_channel_or_per_token_scales__prompt_kernel:
    s_cmp_ge_u32 s2, 256
    s_cbranch_scc1 M_end
    s_load_dwordx16 s[84:99], s[0:1], 0
    s_load_dwordx4 s[68:71], s[0:1], 64
    v_lshrrev_b32 v4, 6, v0
    v_and_b32 v0, 63, v0
    v_readfirstlane_b32 s16, v4
    v_lshlrev_b32 v1, 4, v0
    v_add_u32 v2, 0x10000, v1
    v_and_b32 v8, 15, v0
    v_lshrrev_b32 v9, 4, v0
    s_and_b32 s52, s2, 7
    s_lshr_b32 s53, s2, 3
    s_lshr_b32 s49, s52, 1
    s_and_b32 s52, s52, 1
    s_lshl_b32 s52, s52, 5
    s_add_u32 s48, s52, s53
    s_lshl_b32 s54, s49, 6
    s_add_u32 s54, s54, s48
    s_lshl_b32 s59, s54, 16
    s_lshl_b32 s55, s16, 14
    s_add_u32 s55, s55, s59
    s_lshl_b32 s17, s16, 12
    v_add_u32 v3, s17, v1
    s_lshl_b32 s56, s49, 20
    s_lshl_b32 s57, s49, 9
    s_lshl_b32 s58, s49, 12
    s_lshl_b32 s64, s16, 7
    v_lshlrev_b32 v10, 9, v8
    v_lshl_add_u32 v10, v9, 5, v10
    v_add_u32 v10, s64, v10
    s_lshl_b32 s65, s16, 6
    v_lshlrev_b32 v11, 4, v9
    v_add_u32 v11, s65, v11
    v_lshlrev_b32 v12, 11, v9
    v_lshl_add_u32 v12, v8, 3, v12
    v_add_u32 v12, s64, v12
    v_lshlrev_b32 v13, 3, v9
    v_add_u32 v14, 0, v9
    v_xor_b32 v14, v14, v8
    v_lshlrev_b32 v14, 4, v14
    v_lshl_add_u32 v84, v9, 8, v14
    v_add_u32 v14, 4, v9
    v_xor_b32 v14, v14, v8
    v_lshlrev_b32 v14, 4, v14
    v_lshl_add_u32 v85, v9, 8, v14
    v_add_u32 v14, 8, v9
    v_xor_b32 v14, v14, v8
    v_lshlrev_b32 v14, 4, v14
    v_lshl_add_u32 v86, v9, 8, v14
    v_add_u32 v14, 12, v9
    v_xor_b32 v14, v14, v8
    v_lshlrev_b32 v14, 4, v14
    v_lshl_add_u32 v87, v9, 8, v14
    s_lshl_b32 s60, s16, 13
    s_add_u32 s60, s60, 0x10000
    s_add_u32 s62, s48, 1
    s_and_b32 s62, s62, 63
    s_add_u32 s63, s48, 2
    s_and_b32 s63, s63, 63
    s_mov_b32 s50, 0x3e0293ee
    s_mov_b32 s51, 0xffff0000
    s_waitcnt lgkmcnt(0)
    s_add_u32 s20, s86, s56
    s_addc_u32 s21, s87, 0
    s_and_b32 s21, s21, 0xffff
    s_mov_b32 s22, 1048576
    s_mov_b32 s23, 0x00020000
    s_lshl_b32 s64, s48, 14
    s_add_u32 s65, s64, 0x2000
    s_lshr_b32 s66, s48, 5
    s_lshl_b32 s66, s66, 8
    buffer_load_dwordx4 v[16:19], v10, s[20:23], s64 offen offset:0
    buffer_load_dwordx4 v[20:23], v10, s[20:23], s64 offen offset:16
    buffer_load_dwordx4 v[24:27], v10, s[20:23], s65 offen offset:0
    buffer_load_dwordx4 v[28:31], v10, s[20:23], s65 offen offset:16
    s_add_u32 s28, s90, s57
    s_addc_u32 s29, s91, 0
    s_and_b32 s29, s29, 0xffff
    s_mov_b32 s30, 512
    s_mov_b32 s31, 0x00020000
    s_add_u32 s32, s92, s57
    s_addc_u32 s33, s93, 0
    s_and_b32 s33, s33, 0xffff
    s_mov_b32 s34, 512
    s_mov_b32 s35, 0x00020000
    s_lshl_b32 s64, s48, 14
    s_add_u32 s65, s64, 0x2000
    s_lshr_b32 s66, s48, 5
    s_lshl_b32 s66, s66, 8
    buffer_load_dwordx4 v[32:35], v11, s[28:31], s66 offen
    buffer_load_dwordx4 v[36:39], v11, s[32:35], s66 offen
    s_add_u32 s24, s88, s56
    s_addc_u32 s25, s89, 0
    s_and_b32 s25, s25, 0xffff
    s_mov_b32 s26, 1048576
    s_mov_b32 s27, 0x00020000
    s_lshl_b32 s64, s48, 14
    s_add_u32 s65, s64, 0x2000
    s_lshl_b32 s66, s48, 6
    buffer_load_dwordx2 v[40:41], v12, s[24:27], s64 offen offset:0 nt
    buffer_load_dwordx2 v[42:43], v12, s[24:27], s64 offen offset:512 nt
    buffer_load_dwordx2 v[44:45], v12, s[24:27], s64 offen offset:1024 nt
    buffer_load_dwordx2 v[46:47], v12, s[24:27], s64 offen offset:1536 nt
    buffer_load_dwordx2 v[48:49], v12, s[24:27], s65 offen offset:0 nt
    buffer_load_dwordx2 v[50:51], v12, s[24:27], s65 offen offset:512 nt
    buffer_load_dwordx2 v[52:53], v12, s[24:27], s65 offen offset:1024 nt
    buffer_load_dwordx2 v[54:55], v12, s[24:27], s65 offen offset:1536 nt
    s_add_u32 s36, s94, s58
    s_addc_u32 s37, s95, 0
    s_and_b32 s37, s37, 0xffff
    s_mov_b32 s38, 4096
    s_mov_b32 s39, 0x00020000
    s_add_u32 s40, s96, s58
    s_addc_u32 s41, s97, 0
    s_and_b32 s41, s41, 0xffff
    s_mov_b32 s42, 4096
    s_mov_b32 s43, 0x00020000
    s_lshl_b32 s64, s48, 14
    s_add_u32 s65, s64, 0x2000
    s_lshl_b32 s66, s48, 6
    buffer_load_dwordx2 v[56:57], v13, s[36:39], s66 offen offset:0
    buffer_load_dwordx2 v[58:59], v13, s[36:39], s66 offen offset:32
    buffer_load_dwordx2 v[60:61], v13, s[40:43], s66 offen offset:0
    buffer_load_dwordx2 v[62:63], v13, s[40:43], s66 offen offset:32
    s_add_u32 s4, s84, s55
    s_addc_u32 s5, s85, 0
    s_and_b32 s5, s5, 0xffff
    s_mov_b32 s6, 16384
    s_mov_b32 s7, 0x00020000
    s_add_u32 m0, s60, 0
    s_movk_i32 s61, 0
    buffer_load_dwordx4 v84, s[4:7], s61 offen offset:0 nt lds
    buffer_load_dwordx4 v85, s[4:7], s61 offen offset:1024 nt lds
    buffer_load_dwordx4 v86, s[4:7], s61 offen offset:2048 nt lds
    buffer_load_dwordx4 v87, s[4:7], s61 offen offset:3072 nt lds
    s_add_u32 s12, s98, s55
    s_addc_u32 s13, s99, 0
    s_and_b32 s13, s13, 0xffff
    s_mov_b32 s14, 16384
    s_mov_b32 s15, 0x00020000
    s_add_u32 s8, s70, s56
    s_addc_u32 s9, s71, 0
    s_and_b32 s9, s9, 0xffff
    s_mov_b32 s10, 1048576
    s_mov_b32 s11, 0x00020000
    s_mov_b32 s44, s68
    s_and_b32 s45, s69, 0xffff
    s_mov_b32 s46, 256
    s_mov_b32 s47, 0x00020000
    s_lshl_b32 s59, s16, 10
    v_add_u32 v7, s59, v2
    v_add_u32 v6, s59, v1
    v_add_u32 v5, s59, v6
    s_lshl_b32 s52, s49, 6
    s_waitcnt vmcnt(16)
    v_lshlrev_b32 v64, 16, v32
    v_and_b32 v65, s51, v32
    v_lshlrev_b32 v72, 16, v36
    v_and_b32 v73, s51, v36
    v_lshlrev_b32 v66, 16, v33
    v_and_b32 v67, s51, v33
    v_lshlrev_b32 v74, 16, v37
    v_and_b32 v75, s51, v37
    v_lshlrev_b32 v68, 16, v34
    v_and_b32 v69, s51, v34
    v_lshlrev_b32 v76, 16, v38
    v_and_b32 v77, s51, v38
    v_lshlrev_b32 v70, 16, v35
    v_and_b32 v71, s51, v35
    v_lshlrev_b32 v78, 16, v39
    v_and_b32 v79, s51, v39
    v_cvt_f32_i32 v16, v16
    v_cvt_f32_i32 v17, v17
    v_cvt_pk_bf16_f32 v80, v16, v17
    v_lshlrev_b32 v16, 16, v80
    v_and_b32 v17, s51, v80
    v_sub_f32 v16, v16, v72
    v_sub_f32 v17, v17, v73
    v_cvt_pk_bf16_f32 v80, v16, v17
    v_lshlrev_b32 v16, 16, v80
    v_and_b32 v17, s51, v80
    v_mul_f32 v16, v16, v64
    v_mul_f32 v17, v17, v65
    v_cvt_pk_bf16_f32 v80, v16, v17
    v_lshlrev_b32 v16, 16, v80
    v_and_b32 v17, s51, v80
    v_mul_f32 v16, s50, v16
    v_mul_f32 v17, s50, v17
    v_cvt_pk_bf16_f32 v96, v16, v17
    v_cvt_f32_i32 v18, v18
    v_cvt_f32_i32 v19, v19
    v_cvt_pk_bf16_f32 v80, v18, v19
    v_lshlrev_b32 v18, 16, v80
    v_and_b32 v19, s51, v80
    v_sub_f32 v18, v18, v74
    v_sub_f32 v19, v19, v75
    v_cvt_pk_bf16_f32 v80, v18, v19
    v_lshlrev_b32 v18, 16, v80
    v_and_b32 v19, s51, v80
    v_mul_f32 v18, v18, v66
    v_mul_f32 v19, v19, v67
    v_cvt_pk_bf16_f32 v80, v18, v19
    v_lshlrev_b32 v18, 16, v80
    v_and_b32 v19, s51, v80
    v_mul_f32 v18, s50, v18
    v_mul_f32 v19, s50, v19
    v_cvt_pk_bf16_f32 v97, v18, v19
    v_cvt_f32_i32 v20, v20
    v_cvt_f32_i32 v21, v21
    v_cvt_pk_bf16_f32 v80, v20, v21
    v_lshlrev_b32 v20, 16, v80
    v_and_b32 v21, s51, v80
    v_sub_f32 v20, v20, v76
    v_sub_f32 v21, v21, v77
    v_cvt_pk_bf16_f32 v80, v20, v21
    v_lshlrev_b32 v20, 16, v80
    v_and_b32 v21, s51, v80
    v_mul_f32 v20, v20, v68
    v_mul_f32 v21, v21, v69
    v_cvt_pk_bf16_f32 v80, v20, v21
    v_lshlrev_b32 v20, 16, v80
    v_and_b32 v21, s51, v80
    v_mul_f32 v20, s50, v20
    v_mul_f32 v21, s50, v21
    v_cvt_pk_bf16_f32 v98, v20, v21
    v_cvt_f32_i32 v22, v22
    v_cvt_f32_i32 v23, v23
    v_cvt_pk_bf16_f32 v80, v22, v23
    v_lshlrev_b32 v22, 16, v80
    v_and_b32 v23, s51, v80
    v_sub_f32 v22, v22, v78
    v_sub_f32 v23, v23, v79
    v_cvt_pk_bf16_f32 v80, v22, v23
    v_lshlrev_b32 v22, 16, v80
    v_and_b32 v23, s51, v80
    v_mul_f32 v22, v22, v70
    v_mul_f32 v23, v23, v71
    v_cvt_pk_bf16_f32 v80, v22, v23
    v_lshlrev_b32 v22, 16, v80
    v_and_b32 v23, s51, v80
    v_mul_f32 v22, s50, v22
    v_mul_f32 v23, s50, v23
    v_cvt_pk_bf16_f32 v99, v22, v23
    v_cvt_f32_i32 v24, v24
    v_cvt_f32_i32 v25, v25
    v_cvt_pk_bf16_f32 v80, v24, v25
    v_lshlrev_b32 v24, 16, v80
    v_and_b32 v25, s51, v80
    v_sub_f32 v24, v24, v72
    v_sub_f32 v25, v25, v73
    v_cvt_pk_bf16_f32 v80, v24, v25
    v_lshlrev_b32 v24, 16, v80
    v_and_b32 v25, s51, v80
    v_mul_f32 v24, v24, v64
    v_mul_f32 v25, v25, v65
    v_cvt_pk_bf16_f32 v80, v24, v25
    v_lshlrev_b32 v24, 16, v80
    v_and_b32 v25, s51, v80
    v_mul_f32 v24, s50, v24
    v_mul_f32 v25, s50, v25
    v_cvt_pk_bf16_f32 v100, v24, v25
    v_cvt_f32_i32 v26, v26
    v_cvt_f32_i32 v27, v27
    v_cvt_pk_bf16_f32 v80, v26, v27
    v_lshlrev_b32 v26, 16, v80
    v_and_b32 v27, s51, v80
    v_sub_f32 v26, v26, v74
    v_sub_f32 v27, v27, v75
    v_cvt_pk_bf16_f32 v80, v26, v27
    v_lshlrev_b32 v26, 16, v80
    v_and_b32 v27, s51, v80
    v_mul_f32 v26, v26, v66
    v_mul_f32 v27, v27, v67
    v_cvt_pk_bf16_f32 v80, v26, v27
    v_lshlrev_b32 v26, 16, v80
    v_and_b32 v27, s51, v80
    v_mul_f32 v26, s50, v26
    v_mul_f32 v27, s50, v27
    v_cvt_pk_bf16_f32 v101, v26, v27
    v_cvt_f32_i32 v28, v28
    v_cvt_f32_i32 v29, v29
    v_cvt_pk_bf16_f32 v80, v28, v29
    v_lshlrev_b32 v28, 16, v80
    v_and_b32 v29, s51, v80
    v_sub_f32 v28, v28, v76
    v_sub_f32 v29, v29, v77
    v_cvt_pk_bf16_f32 v80, v28, v29
    v_lshlrev_b32 v28, 16, v80
    v_and_b32 v29, s51, v80
    v_mul_f32 v28, v28, v68
    v_mul_f32 v29, v29, v69
    v_cvt_pk_bf16_f32 v80, v28, v29
    v_lshlrev_b32 v28, 16, v80
    v_and_b32 v29, s51, v80
    v_mul_f32 v28, s50, v28
    v_mul_f32 v29, s50, v29
    v_cvt_pk_bf16_f32 v102, v28, v29
    v_cvt_f32_i32 v30, v30
    v_cvt_f32_i32 v31, v31
    v_cvt_pk_bf16_f32 v80, v30, v31
    v_lshlrev_b32 v30, 16, v80
    v_and_b32 v31, s51, v80
    v_sub_f32 v30, v30, v78
    v_sub_f32 v31, v31, v79
    v_cvt_pk_bf16_f32 v80, v30, v31
    v_lshlrev_b32 v30, 16, v80
    v_and_b32 v31, s51, v80
    v_mul_f32 v30, v30, v70
    v_mul_f32 v31, v31, v71
    v_cvt_pk_bf16_f32 v80, v30, v31
    v_lshlrev_b32 v30, 16, v80
    v_and_b32 v31, s51, v80
    v_mul_f32 v30, s50, v30
    v_mul_f32 v31, s50, v31
    v_cvt_pk_bf16_f32 v103, v30, v31
    s_add_u32 s64, s48, 62
    s_and_b32 s64, s64, 63
    s_lshl_b32 s64, s64, 14
    s_lshl_b32 s65, s16, 10
    s_add_u32 s64, s64, s65
    s_add_u32 s66, s64, 0x1000
    s_lshl_b32 s67, s48, 14
    s_add_u32 s67, s67, 0x2000
    s_add_u32 s67, s67, s65
    s_add_u32 s67, s67, s65
    buffer_store_dwordx4 v[96:99], v1, s[8:11], s64 offen sc1
    buffer_store_dwordx4 v[100:103], v1, s[8:11], s66 offen sc1
    ds_write_b128 v7, v[96:99] offset:32768
    ds_write_b128 v7, v[100:103] offset:36864
    s_waitcnt vmcnt(6)
    v_lshlrev_b32 v64, 16, v56
    v_and_b32 v65, s51, v56
    v_lshlrev_b32 v72, 16, v60
    v_and_b32 v73, s51, v60
    v_lshlrev_b32 v66, 16, v57
    v_and_b32 v67, s51, v57
    v_lshlrev_b32 v74, 16, v61
    v_and_b32 v75, s51, v61
    v_lshlrev_b32 v68, 16, v58
    v_and_b32 v69, s51, v58
    v_lshlrev_b32 v76, 16, v62
    v_and_b32 v77, s51, v62
    v_lshlrev_b32 v70, 16, v59
    v_and_b32 v71, s51, v59
    v_lshlrev_b32 v78, 16, v63
    v_and_b32 v79, s51, v63
    v_cvt_f32_i32 v40, v40
    v_cvt_f32_i32 v42, v42
    v_cvt_pk_bf16_f32 v80, v40, v42
    v_lshlrev_b32 v40, 16, v80
    v_and_b32 v42, s51, v80
    v_sub_f32 v40, v40, v72
    v_sub_f32 v42, v42, v73
    v_cvt_pk_bf16_f32 v80, v40, v42
    v_lshlrev_b32 v40, 16, v80
    v_and_b32 v42, s51, v80
    v_mul_f32 v40, v40, v64
    v_mul_f32 v42, v42, v65
    v_cvt_pk_bf16_f32 v104, v40, v42
    v_cvt_f32_i32 v44, v44
    v_cvt_f32_i32 v46, v46
    v_cvt_pk_bf16_f32 v80, v44, v46
    v_lshlrev_b32 v44, 16, v80
    v_and_b32 v46, s51, v80
    v_sub_f32 v44, v44, v74
    v_sub_f32 v46, v46, v75
    v_cvt_pk_bf16_f32 v80, v44, v46
    v_lshlrev_b32 v44, 16, v80
    v_and_b32 v46, s51, v80
    v_mul_f32 v44, v44, v66
    v_mul_f32 v46, v46, v67
    v_cvt_pk_bf16_f32 v105, v44, v46
    v_cvt_f32_i32 v48, v48
    v_cvt_f32_i32 v50, v50
    v_cvt_pk_bf16_f32 v80, v48, v50
    v_lshlrev_b32 v48, 16, v80
    v_and_b32 v50, s51, v80
    v_sub_f32 v48, v48, v76
    v_sub_f32 v50, v50, v77
    v_cvt_pk_bf16_f32 v80, v48, v50
    v_lshlrev_b32 v48, 16, v80
    v_and_b32 v50, s51, v80
    v_mul_f32 v48, v48, v68
    v_mul_f32 v50, v50, v69
    v_cvt_pk_bf16_f32 v106, v48, v50
    v_cvt_f32_i32 v52, v52
    v_cvt_f32_i32 v54, v54
    v_cvt_pk_bf16_f32 v80, v52, v54
    v_lshlrev_b32 v52, 16, v80
    v_and_b32 v54, s51, v80
    v_sub_f32 v52, v52, v78
    v_sub_f32 v54, v54, v79
    v_cvt_pk_bf16_f32 v80, v52, v54
    v_lshlrev_b32 v52, 16, v80
    v_and_b32 v54, s51, v80
    v_mul_f32 v52, v52, v70
    v_mul_f32 v54, v54, v71
    v_cvt_pk_bf16_f32 v107, v52, v54
    v_cvt_f32_i32 v41, v41
    v_cvt_f32_i32 v43, v43
    v_cvt_pk_bf16_f32 v80, v41, v43
    v_lshlrev_b32 v41, 16, v80
    v_and_b32 v43, s51, v80
    v_sub_f32 v41, v41, v72
    v_sub_f32 v43, v43, v73
    v_cvt_pk_bf16_f32 v80, v41, v43
    v_lshlrev_b32 v41, 16, v80
    v_and_b32 v43, s51, v80
    v_mul_f32 v41, v41, v64
    v_mul_f32 v43, v43, v65
    v_cvt_pk_bf16_f32 v108, v41, v43
    v_cvt_f32_i32 v45, v45
    v_cvt_f32_i32 v47, v47
    v_cvt_pk_bf16_f32 v80, v45, v47
    v_lshlrev_b32 v45, 16, v80
    v_and_b32 v47, s51, v80
    v_sub_f32 v45, v45, v74
    v_sub_f32 v47, v47, v75
    v_cvt_pk_bf16_f32 v80, v45, v47
    v_lshlrev_b32 v45, 16, v80
    v_and_b32 v47, s51, v80
    v_mul_f32 v45, v45, v66
    v_mul_f32 v47, v47, v67
    v_cvt_pk_bf16_f32 v109, v45, v47
    v_cvt_f32_i32 v49, v49
    v_cvt_f32_i32 v51, v51
    v_cvt_pk_bf16_f32 v80, v49, v51
    v_lshlrev_b32 v49, 16, v80
    v_and_b32 v51, s51, v80
    v_sub_f32 v49, v49, v76
    v_sub_f32 v51, v51, v77
    v_cvt_pk_bf16_f32 v80, v49, v51
    v_lshlrev_b32 v49, 16, v80
    v_and_b32 v51, s51, v80
    v_mul_f32 v49, v49, v68
    v_mul_f32 v51, v51, v69
    v_cvt_pk_bf16_f32 v110, v49, v51
    v_cvt_f32_i32 v53, v53
    v_cvt_f32_i32 v55, v55
    v_cvt_pk_bf16_f32 v80, v53, v55
    v_lshlrev_b32 v53, 16, v80
    v_and_b32 v55, s51, v80
    v_sub_f32 v53, v53, v78
    v_sub_f32 v55, v55, v79
    v_cvt_pk_bf16_f32 v80, v53, v55
    v_lshlrev_b32 v53, 16, v80
    v_and_b32 v55, s51, v80
    v_mul_f32 v53, v53, v70
    v_mul_f32 v55, v55, v71
    v_cvt_pk_bf16_f32 v111, v53, v55
    s_add_u32 s64, s48, 62
    s_and_b32 s64, s64, 63
    s_lshl_b32 s64, s64, 14
    s_lshl_b32 s65, s16, 10
    s_add_u32 s64, s64, s65
    s_add_u32 s66, s64, 0x1000
    s_lshl_b32 s67, s48, 14
    s_add_u32 s67, s67, 0x2000
    s_add_u32 s67, s67, s65
    s_add_u32 s67, s67, s65
    buffer_store_dwordx4 v[104:107], v1, s[8:11], s67 offen sc1
    buffer_store_dwordx4 v[108:111], v1, s[8:11], s67 offen offset:1024 sc1
    ds_write_b128 v5, v[104:107] offset:8192
    ds_write_b128 v5, v[108:111] offset:9216
    s_lshl_b32 s64, s62, 14
    s_add_u32 s65, s64, 0x2000
    s_lshr_b32 s66, s62, 5
    s_lshl_b32 s66, s66, 8
    buffer_load_dwordx4 v[16:19], v10, s[20:23], s64 offen offset:0
    buffer_load_dwordx4 v[20:23], v10, s[20:23], s64 offen offset:16
    buffer_load_dwordx4 v[24:27], v10, s[20:23], s65 offen offset:0
    buffer_load_dwordx4 v[28:31], v10, s[20:23], s65 offen offset:16
    buffer_load_dwordx4 v[32:35], v11, s[28:31], s66 offen
    buffer_load_dwordx4 v[36:39], v11, s[32:35], s66 offen
    s_lshl_b32 s64, s63, 14
    s_add_u32 s65, s64, 0x2000
    s_lshr_b32 s66, s63, 5
    s_lshl_b32 s66, s66, 8
    buffer_load_dwordx4 v[40:43], v10, s[20:23], s64 offen offset:0
    buffer_load_dwordx4 v[44:47], v10, s[20:23], s64 offen offset:16
    buffer_load_dwordx4 v[48:51], v10, s[20:23], s65 offen offset:0
    buffer_load_dwordx4 v[52:55], v10, s[20:23], s65 offen offset:16
    buffer_load_dwordx4 v[56:59], v11, s[28:31], s66 offen
    buffer_load_dwordx4 v[60:63], v11, s[32:35], s66 offen
    s_add_u32 m0, s60, 4096
    s_movk_i32 s61, 4096
    buffer_load_dwordx4 v84, s[4:7], s61 offen offset:0 nt lds
    buffer_load_dwordx4 v85, s[4:7], s61 offen offset:1024 nt lds
    buffer_load_dwordx4 v86, s[4:7], s61 offen offset:2048 nt lds
    buffer_load_dwordx4 v87, s[4:7], s61 offen offset:3072 nt lds
    v_add_u32 v92, 0, v9
    v_xor_b32 v92, v92, v8
    v_lshlrev_b32 v92, 4, v92
    v_lshl_add_u32 v92, v8, 8, v92
    v_add_u32 v88, s60, v92
    v_add_u32 v92, 4, v9
    v_xor_b32 v92, v92, v8
    v_lshlrev_b32 v92, 4, v92
    v_lshl_add_u32 v92, v8, 8, v92
    v_add_u32 v89, s60, v92
    v_add_u32 v92, 8, v9
    v_xor_b32 v92, v92, v8
    v_lshlrev_b32 v92, 4, v92
    v_lshl_add_u32 v92, v8, 8, v92
    v_add_u32 v90, s60, v92
    v_add_u32 v92, 12, v9
    v_xor_b32 v92, v92, v8
    v_lshlrev_b32 v92, 4, v92
    v_lshl_add_u32 v92, v8, 8, v92
    v_add_u32 v91, s60, v92
    s_lshl_b32 s18, s48, 14
    v_mov_b32 v128, 0
    v_mov_b32 v129, 0
    v_mov_b32 v130, 0
    v_mov_b32 v131, 0
    v_mov_b32 v132, 0
    v_mov_b32 v133, 0
    v_mov_b32 v134, 0
    v_mov_b32 v135, 0
    v_mov_b32 v136, 0
    v_mov_b32 v137, 0
    v_mov_b32 v138, 0
    v_mov_b32 v139, 0
    v_mov_b32 v140, 0
    v_mov_b32 v141, 0
    v_mov_b32 v142, 0
    v_mov_b32 v143, 0
    v_mov_b32 v144, 0
    v_mov_b32 v145, 0
    v_mov_b32 v146, 0
    v_mov_b32 v147, 0
    v_mov_b32 v148, 0
    v_mov_b32 v149, 0
    v_mov_b32 v150, 0
    v_mov_b32 v151, 0
    v_mov_b32 v152, 0
    v_mov_b32 v153, 0
    v_mov_b32 v154, 0
    v_mov_b32 v155, 0
    v_mov_b32 v156, 0
    v_mov_b32 v157, 0
    v_mov_b32 v158, 0
    v_mov_b32 v159, 0
    v_mov_b32 v160, 0
    v_mov_b32 v161, 0
    v_mov_b32 v162, 0
    v_mov_b32 v163, 0
    v_mov_b32 v164, 0
    v_mov_b32 v165, 0
    v_mov_b32 v166, 0
    v_mov_b32 v167, 0
    v_mov_b32 v168, 0
    v_mov_b32 v169, 0
    v_mov_b32 v170, 0
    v_mov_b32 v171, 0
    v_mov_b32 v172, 0
    v_mov_b32 v173, 0
    v_mov_b32 v174, 0
    v_mov_b32 v175, 0
    v_mov_b32 v176, 0
    v_mov_b32 v177, 0
    v_mov_b32 v178, 0
    v_mov_b32 v179, 0
    v_mov_b32 v180, 0
    v_mov_b32 v181, 0
    v_mov_b32 v182, 0
    v_mov_b32 v183, 0
    v_mov_b32 v184, 0
    v_mov_b32 v185, 0
    v_mov_b32 v186, 0
    v_mov_b32 v187, 0
    v_mov_b32 v188, 0
    v_mov_b32 v189, 0
    v_mov_b32 v190, 0
    v_mov_b32 v191, 0
    v_mov_b32 v192, 0
    v_mov_b32 v193, 0
    v_mov_b32 v194, 0
    v_mov_b32 v195, 0
    v_mov_b32 v196, 0
    v_mov_b32 v197, 0
    v_mov_b32 v198, 0
    v_mov_b32 v199, 0
    v_mov_b32 v200, 0
    v_mov_b32 v201, 0
    v_mov_b32 v202, 0
    v_mov_b32 v203, 0
    v_mov_b32 v204, 0
    v_mov_b32 v205, 0
    v_mov_b32 v206, 0
    v_mov_b32 v207, 0
    v_mov_b32 v208, 0
    v_mov_b32 v209, 0
    v_mov_b32 v210, 0
    v_mov_b32 v211, 0
    v_mov_b32 v212, 0
    v_mov_b32 v213, 0
    v_mov_b32 v214, 0
    v_mov_b32 v215, 0
    v_mov_b32 v216, 0
    v_mov_b32 v217, 0
    v_mov_b32 v218, 0
    v_mov_b32 v219, 0
    v_mov_b32 v220, 0
    v_mov_b32 v221, 0
    v_mov_b32 v222, 0
    v_mov_b32 v223, 0
    v_mov_b32 v224, 0
    v_mov_b32 v225, 0
    v_mov_b32 v226, 0
    v_mov_b32 v227, 0
    v_mov_b32 v228, 0
    v_mov_b32 v229, 0
    v_mov_b32 v230, 0
    v_mov_b32 v231, 0
    v_mov_b32 v232, 0
    v_mov_b32 v233, 0
    v_mov_b32 v234, 0
    v_mov_b32 v235, 0
    v_mov_b32 v236, 0
    v_mov_b32 v237, 0
    v_mov_b32 v238, 0
    v_mov_b32 v239, 0
    v_mov_b32 v240, 0
    v_mov_b32 v241, 0
    v_mov_b32 v242, 0
    v_mov_b32 v243, 0
    v_mov_b32 v244, 0
    v_mov_b32 v245, 0
    v_mov_b32 v246, 0
    v_mov_b32 v247, 0
    v_mov_b32 v248, 0
    v_mov_b32 v249, 0
    v_mov_b32 v250, 0
    v_mov_b32 v251, 0
    v_mov_b32 v252, 0
    v_mov_b32 v253, 0
    v_mov_b32 v254, 0
    v_mov_b32 v255, 0
    v_accvgpr_write_b32 a116, 0
    v_accvgpr_write_b32 a117, 0
    v_accvgpr_write_b32 a118, 0
    v_accvgpr_write_b32 a119, 0
    v_accvgpr_write_b32 a120, 0
    v_accvgpr_write_b32 a121, 0
    v_accvgpr_write_b32 a122, 0
    v_accvgpr_write_b32 a123, 0
    v_accvgpr_write_b32 a124, 0
    v_accvgpr_write_b32 a125, 0
    v_accvgpr_write_b32 a126, 0
    v_accvgpr_write_b32 a127, 0
    v_accvgpr_write_b32 a128, 0
    v_accvgpr_write_b32 a129, 0
    v_accvgpr_write_b32 a130, 0
    v_accvgpr_write_b32 a131, 0
    v_mov_b32 v92, 0x3f803f80
    v_accvgpr_write_b32 a112, v92
    v_accvgpr_write_b32 a113, v92
    v_accvgpr_write_b32 a114, v92
    v_accvgpr_write_b32 a115, v92
    v_mov_b32 v14, 1
    v_mov_b32 v15, 0
    s_waitcnt vmcnt(16) lgkmcnt(0)
    s_barrier
    s_cmp_lg_u32 s16, 0
    s_cbranch_scc1 M_noflag
    s_mov_b64 exec, 1
    buffer_atomic_add v14, v15, s[44:47], s52 offen sc1
    s_mov_b64 exec, -1
M_noflag:
    v_add_u32 v12, 0x10000, v88
    v_add_u32 v13, 0x10000, v89
    v_add_u32 v14, 0x10000, v90
    v_add_u32 v15, 0x10000, v91
    s_add_u32 m0, s60, 65536
    s_movk_i32 s61, 8192
    buffer_load_dwordx4 v84, s[4:7], s61 offen offset:0 nt lds
    buffer_load_dwordx4 v85, s[4:7], s61 offen offset:1024 nt lds
    buffer_load_dwordx4 v86, s[4:7], s61 offen offset:2048 nt lds
    buffer_load_dwordx4 v87, s[4:7], s61 offen offset:3072 nt lds
    s_waitcnt vmcnt(14)
    v_lshlrev_b32 v64, 16, v32
    v_and_b32 v65, s51, v32
    v_lshlrev_b32 v72, 16, v36
    v_and_b32 v73, s51, v36
    v_lshlrev_b32 v66, 16, v33
    v_and_b32 v67, s51, v33
    v_lshlrev_b32 v74, 16, v37
    v_and_b32 v75, s51, v37
    v_lshlrev_b32 v68, 16, v34
    v_and_b32 v69, s51, v34
    v_lshlrev_b32 v76, 16, v38
    v_and_b32 v77, s51, v38
    v_lshlrev_b32 v70, 16, v35
    v_and_b32 v71, s51, v35
    v_lshlrev_b32 v78, 16, v39
    v_and_b32 v79, s51, v39
    v_cvt_f32_i32 v16, v16
    v_cvt_f32_i32 v17, v17
    v_cvt_pk_bf16_f32 v80, v16, v17
    v_lshlrev_b32 v16, 16, v80
    v_and_b32 v17, s51, v80
    v_sub_f32 v16, v16, v72
    v_sub_f32 v17, v17, v73
    v_cvt_pk_bf16_f32 v80, v16, v17
    v_lshlrev_b32 v16, 16, v80
    v_and_b32 v17, s51, v80
    v_mul_f32 v16, v16, v64
    v_mul_f32 v17, v17, v65
    v_cvt_pk_bf16_f32 v80, v16, v17
    v_lshlrev_b32 v16, 16, v80
    v_and_b32 v17, s51, v80
    v_mul_f32 v16, s50, v16
    v_mul_f32 v17, s50, v17
    v_cvt_pk_bf16_f32 v112, v16, v17
    v_cvt_f32_i32 v18, v18
    v_cvt_f32_i32 v19, v19
    v_cvt_pk_bf16_f32 v80, v18, v19
    v_lshlrev_b32 v18, 16, v80
    v_and_b32 v19, s51, v80
    v_sub_f32 v18, v18, v74
    v_sub_f32 v19, v19, v75
    v_cvt_pk_bf16_f32 v80, v18, v19
    v_lshlrev_b32 v18, 16, v80
    v_and_b32 v19, s51, v80
    v_mul_f32 v18, v18, v66
    v_mul_f32 v19, v19, v67
    v_cvt_pk_bf16_f32 v80, v18, v19
    v_lshlrev_b32 v18, 16, v80
    v_and_b32 v19, s51, v80
    v_mul_f32 v18, s50, v18
    v_mul_f32 v19, s50, v19
    v_cvt_pk_bf16_f32 v113, v18, v19
    v_cvt_f32_i32 v20, v20
    v_cvt_f32_i32 v21, v21
    v_cvt_pk_bf16_f32 v80, v20, v21
    v_lshlrev_b32 v20, 16, v80
    v_and_b32 v21, s51, v80
    v_sub_f32 v20, v20, v76
    v_sub_f32 v21, v21, v77
    v_cvt_pk_bf16_f32 v80, v20, v21
    v_lshlrev_b32 v20, 16, v80
    v_and_b32 v21, s51, v80
    v_mul_f32 v20, v20, v68
    v_mul_f32 v21, v21, v69
    v_cvt_pk_bf16_f32 v80, v20, v21
    v_lshlrev_b32 v20, 16, v80
    v_and_b32 v21, s51, v80
    v_mul_f32 v20, s50, v20
    v_mul_f32 v21, s50, v21
    v_cvt_pk_bf16_f32 v114, v20, v21
    v_cvt_f32_i32 v22, v22
    v_cvt_f32_i32 v23, v23
    v_cvt_pk_bf16_f32 v80, v22, v23
    v_lshlrev_b32 v22, 16, v80
    v_and_b32 v23, s51, v80
    v_sub_f32 v22, v22, v78
    v_sub_f32 v23, v23, v79
    v_cvt_pk_bf16_f32 v80, v22, v23
    v_lshlrev_b32 v22, 16, v80
    v_and_b32 v23, s51, v80
    v_mul_f32 v22, v22, v70
    v_mul_f32 v23, v23, v71
    v_cvt_pk_bf16_f32 v80, v22, v23
    v_lshlrev_b32 v22, 16, v80
    v_and_b32 v23, s51, v80
    v_mul_f32 v22, s50, v22
    v_mul_f32 v23, s50, v23
    v_cvt_pk_bf16_f32 v115, v22, v23
    v_cvt_f32_i32 v24, v24
    v_cvt_f32_i32 v25, v25
    v_cvt_pk_bf16_f32 v80, v24, v25
    v_lshlrev_b32 v24, 16, v80
    v_and_b32 v25, s51, v80
    v_sub_f32 v24, v24, v72
    v_sub_f32 v25, v25, v73
    v_cvt_pk_bf16_f32 v80, v24, v25
    v_lshlrev_b32 v24, 16, v80
    v_and_b32 v25, s51, v80
    v_mul_f32 v24, v24, v64
    v_mul_f32 v25, v25, v65
    v_cvt_pk_bf16_f32 v80, v24, v25
    v_lshlrev_b32 v24, 16, v80
    v_and_b32 v25, s51, v80
    v_mul_f32 v24, s50, v24
    v_mul_f32 v25, s50, v25
    v_cvt_pk_bf16_f32 v116, v24, v25
    v_cvt_f32_i32 v26, v26
    v_cvt_f32_i32 v27, v27
    v_cvt_pk_bf16_f32 v80, v26, v27
    v_lshlrev_b32 v26, 16, v80
    v_and_b32 v27, s51, v80
    v_sub_f32 v26, v26, v74
    v_sub_f32 v27, v27, v75
    v_cvt_pk_bf16_f32 v80, v26, v27
    v_lshlrev_b32 v26, 16, v80
    v_and_b32 v27, s51, v80
    v_mul_f32 v26, v26, v66
    v_mul_f32 v27, v27, v67
    v_cvt_pk_bf16_f32 v80, v26, v27
    v_lshlrev_b32 v26, 16, v80
    v_and_b32 v27, s51, v80
    v_mul_f32 v26, s50, v26
    v_mul_f32 v27, s50, v27
    v_cvt_pk_bf16_f32 v117, v26, v27
    v_cvt_f32_i32 v28, v28
    v_cvt_f32_i32 v29, v29
    v_cvt_pk_bf16_f32 v80, v28, v29
    v_lshlrev_b32 v28, 16, v80
    v_and_b32 v29, s51, v80
    v_sub_f32 v28, v28, v76
    v_sub_f32 v29, v29, v77
    v_cvt_pk_bf16_f32 v80, v28, v29
    v_lshlrev_b32 v28, 16, v80
    v_and_b32 v29, s51, v80
    v_mul_f32 v28, v28, v68
    v_mul_f32 v29, v29, v69
    v_cvt_pk_bf16_f32 v80, v28, v29
    v_lshlrev_b32 v28, 16, v80
    v_and_b32 v29, s51, v80
    v_mul_f32 v28, s50, v28
    v_mul_f32 v29, s50, v29
    v_cvt_pk_bf16_f32 v118, v28, v29
    v_cvt_f32_i32 v30, v30
    v_cvt_f32_i32 v31, v31
    v_cvt_pk_bf16_f32 v80, v30, v31
    v_lshlrev_b32 v30, 16, v80
    v_and_b32 v31, s51, v80
    v_sub_f32 v30, v30, v78
    v_sub_f32 v31, v31, v79
    v_cvt_pk_bf16_f32 v80, v30, v31
    v_lshlrev_b32 v30, 16, v80
    v_and_b32 v31, s51, v80
    v_mul_f32 v30, v30, v70
    v_mul_f32 v31, v31, v71
    v_cvt_pk_bf16_f32 v80, v30, v31
    v_lshlrev_b32 v30, 16, v80
    v_and_b32 v31, s51, v80
    v_mul_f32 v30, s50, v30
    v_mul_f32 v31, s50, v31
    v_cvt_pk_bf16_f32 v119, v30, v31
    ds_write_b128 v7, v[112:115] offset:49152
    ds_write_b128 v7, v[116:119] offset:53248
    s_add_u32 m0, s60, 69632
    s_movk_i32 s61, 12288
    buffer_load_dwordx4 v84, s[4:7], s61 offen offset:0 nt lds
    buffer_load_dwordx4 v85, s[4:7], s61 offen offset:1024 nt lds
    buffer_load_dwordx4 v86, s[4:7], s61 offen offset:2048 nt lds
    buffer_load_dwordx4 v87, s[4:7], s61 offen offset:3072 nt lds
    s_waitcnt vmcnt(12)
    v_lshlrev_b32 v64, 16, v56
    v_and_b32 v65, s51, v56
    v_lshlrev_b32 v72, 16, v60
    v_and_b32 v73, s51, v60
    v_lshlrev_b32 v66, 16, v57
    v_and_b32 v67, s51, v57
    v_lshlrev_b32 v74, 16, v61
    v_and_b32 v75, s51, v61
    v_lshlrev_b32 v68, 16, v58
    v_and_b32 v69, s51, v58
    v_lshlrev_b32 v76, 16, v62
    v_and_b32 v77, s51, v62
    v_lshlrev_b32 v70, 16, v59
    v_and_b32 v71, s51, v59
    v_lshlrev_b32 v78, 16, v63
    v_and_b32 v79, s51, v63
    v_cvt_f32_i32 v40, v40
    v_cvt_f32_i32 v41, v41
    v_cvt_pk_bf16_f32 v80, v40, v41
    v_lshlrev_b32 v40, 16, v80
    v_and_b32 v41, s51, v80
    v_sub_f32 v40, v40, v72
    v_sub_f32 v41, v41, v73
    v_cvt_pk_bf16_f32 v80, v40, v41
    v_lshlrev_b32 v40, 16, v80
    v_and_b32 v41, s51, v80
    v_mul_f32 v40, v40, v64
    v_mul_f32 v41, v41, v65
    v_cvt_pk_bf16_f32 v80, v40, v41
    v_lshlrev_b32 v40, 16, v80
    v_and_b32 v41, s51, v80
    v_mul_f32 v40, s50, v40
    v_mul_f32 v41, s50, v41
    v_cvt_pk_bf16_f32 v120, v40, v41
    v_cvt_f32_i32 v42, v42
    v_cvt_f32_i32 v43, v43
    v_cvt_pk_bf16_f32 v80, v42, v43
    v_lshlrev_b32 v42, 16, v80
    v_and_b32 v43, s51, v80
    v_sub_f32 v42, v42, v74
    v_sub_f32 v43, v43, v75
    v_cvt_pk_bf16_f32 v80, v42, v43
    v_lshlrev_b32 v42, 16, v80
    v_and_b32 v43, s51, v80
    v_mul_f32 v42, v42, v66
    v_mul_f32 v43, v43, v67
    v_cvt_pk_bf16_f32 v80, v42, v43
    v_lshlrev_b32 v42, 16, v80
    v_and_b32 v43, s51, v80
    v_mul_f32 v42, s50, v42
    v_mul_f32 v43, s50, v43
    v_cvt_pk_bf16_f32 v121, v42, v43
    v_cvt_f32_i32 v44, v44
    v_cvt_f32_i32 v45, v45
    v_cvt_pk_bf16_f32 v80, v44, v45
    v_lshlrev_b32 v44, 16, v80
    v_and_b32 v45, s51, v80
    v_sub_f32 v44, v44, v76
    v_sub_f32 v45, v45, v77
    v_cvt_pk_bf16_f32 v80, v44, v45
    v_lshlrev_b32 v44, 16, v80
    v_and_b32 v45, s51, v80
    v_mul_f32 v44, v44, v68
    v_mul_f32 v45, v45, v69
    v_cvt_pk_bf16_f32 v80, v44, v45
    v_lshlrev_b32 v44, 16, v80
    v_and_b32 v45, s51, v80
    v_mul_f32 v44, s50, v44
    v_mul_f32 v45, s50, v45
    v_cvt_pk_bf16_f32 v122, v44, v45
    v_cvt_f32_i32 v46, v46
    v_cvt_f32_i32 v47, v47
    v_cvt_pk_bf16_f32 v80, v46, v47
    v_lshlrev_b32 v46, 16, v80
    v_and_b32 v47, s51, v80
    v_sub_f32 v46, v46, v78
    v_sub_f32 v47, v47, v79
    v_cvt_pk_bf16_f32 v80, v46, v47
    v_lshlrev_b32 v46, 16, v80
    v_and_b32 v47, s51, v80
    v_mul_f32 v46, v46, v70
    v_mul_f32 v47, v47, v71
    v_cvt_pk_bf16_f32 v80, v46, v47
    v_lshlrev_b32 v46, 16, v80
    v_and_b32 v47, s51, v80
    v_mul_f32 v46, s50, v46
    v_mul_f32 v47, s50, v47
    v_cvt_pk_bf16_f32 v123, v46, v47
    v_cvt_f32_i32 v48, v48
    v_cvt_f32_i32 v49, v49
    v_cvt_pk_bf16_f32 v80, v48, v49
    v_lshlrev_b32 v48, 16, v80
    v_and_b32 v49, s51, v80
    v_sub_f32 v48, v48, v72
    v_sub_f32 v49, v49, v73
    v_cvt_pk_bf16_f32 v80, v48, v49
    v_lshlrev_b32 v48, 16, v80
    v_and_b32 v49, s51, v80
    v_mul_f32 v48, v48, v64
    v_mul_f32 v49, v49, v65
    v_cvt_pk_bf16_f32 v80, v48, v49
    v_lshlrev_b32 v48, 16, v80
    v_and_b32 v49, s51, v80
    v_mul_f32 v48, s50, v48
    v_mul_f32 v49, s50, v49
    v_cvt_pk_bf16_f32 v124, v48, v49
    v_cvt_f32_i32 v50, v50
    v_cvt_f32_i32 v51, v51
    v_cvt_pk_bf16_f32 v80, v50, v51
    v_lshlrev_b32 v50, 16, v80
    v_and_b32 v51, s51, v80
    v_sub_f32 v50, v50, v74
    v_sub_f32 v51, v51, v75
    v_cvt_pk_bf16_f32 v80, v50, v51
    v_lshlrev_b32 v50, 16, v80
    v_and_b32 v51, s51, v80
    v_mul_f32 v50, v50, v66
    v_mul_f32 v51, v51, v67
    v_cvt_pk_bf16_f32 v80, v50, v51
    v_lshlrev_b32 v50, 16, v80
    v_and_b32 v51, s51, v80
    v_mul_f32 v50, s50, v50
    v_mul_f32 v51, s50, v51
    v_cvt_pk_bf16_f32 v125, v50, v51
    v_cvt_f32_i32 v52, v52
    v_cvt_f32_i32 v53, v53
    v_cvt_pk_bf16_f32 v80, v52, v53
    v_lshlrev_b32 v52, 16, v80
    v_and_b32 v53, s51, v80
    v_sub_f32 v52, v52, v76
    v_sub_f32 v53, v53, v77
    v_cvt_pk_bf16_f32 v80, v52, v53
    v_lshlrev_b32 v52, 16, v80
    v_and_b32 v53, s51, v80
    v_mul_f32 v52, v52, v68
    v_mul_f32 v53, v53, v69
    v_cvt_pk_bf16_f32 v80, v52, v53
    v_lshlrev_b32 v52, 16, v80
    v_and_b32 v53, s51, v80
    v_mul_f32 v52, s50, v52
    v_mul_f32 v53, s50, v53
    v_cvt_pk_bf16_f32 v126, v52, v53
    v_cvt_f32_i32 v54, v54
    v_cvt_f32_i32 v55, v55
    v_cvt_pk_bf16_f32 v80, v54, v55
    v_lshlrev_b32 v54, 16, v80
    v_and_b32 v55, s51, v80
    v_sub_f32 v54, v54, v78
    v_sub_f32 v55, v55, v79
    v_cvt_pk_bf16_f32 v80, v54, v55
    v_lshlrev_b32 v54, 16, v80
    v_and_b32 v55, s51, v80
    v_mul_f32 v54, v54, v70
    v_mul_f32 v55, v55, v71
    v_cvt_pk_bf16_f32 v80, v54, v55
    v_lshlrev_b32 v54, 16, v80
    v_and_b32 v55, s51, v80
    v_mul_f32 v54, s50, v54
    v_mul_f32 v55, s50, v55
    v_cvt_pk_bf16_f32 v127, v54, v55
    ds_write_b128 v6, v[120:123] offset:0
    ds_write_b128 v6, v[124:127] offset:4096
    ds_read_b128 a[64:67], v2 offset:32768
    ds_read_b128 a[68:71], v2 offset:33792
    ds_read_b128 a[72:75], v2 offset:34816
    ds_read_b128 a[76:79], v2 offset:35840
    ds_read_b128 a[80:83], v2 offset:36864
    ds_read_b128 a[84:87], v2 offset:37888
    ds_read_b128 a[88:91], v2 offset:38912
    ds_read_b128 a[92:95], v2 offset:39936
    s_waitcnt vmcnt(28)
    ds_read_b128 a[0:3], v88 offset:0
    ds_read_b128 a[4:7], v89 offset:0
    ds_read_b128 a[8:11], v90 offset:0
    ds_read_b128 a[12:15], v91 offset:0
    s_waitcnt lgkmcnt(0)
    v_mfma_f32_16x16x32_bf16 v[16:19], a[64:67], a[0:3], 0
    v_mfma_f32_16x16x32_bf16 v[16:19], a[68:71], a[4:7], v[16:19]
    v_mfma_f32_16x16x32_bf16 v[16:19], a[72:75], a[8:11], v[16:19]
    v_mfma_f32_16x16x32_bf16 v[16:19], a[76:79], a[12:15], v[16:19]
    v_mfma_f32_16x16x32_bf16 v[32:35], a[80:83], a[0:3], 0
    v_mfma_f32_16x16x32_bf16 v[32:35], a[84:87], a[4:7], v[32:35]
    v_mfma_f32_16x16x32_bf16 v[32:35], a[88:91], a[8:11], v[32:35]
    v_mfma_f32_16x16x32_bf16 v[32:35], a[92:95], a[12:15], v[32:35]
    s_waitcnt vmcnt(8)
    ds_read_b128 a[16:19], v88 offset:4096
    ds_read_b128 a[20:23], v89 offset:4096
    ds_read_b128 a[24:27], v90 offset:4096
    ds_read_b128 a[28:31], v91 offset:4096
    s_waitcnt lgkmcnt(0)
    v_mfma_f32_16x16x32_bf16 v[20:23], a[64:67], a[16:19], 0
    v_mfma_f32_16x16x32_bf16 v[20:23], a[68:71], a[20:23], v[20:23]
    v_mfma_f32_16x16x32_bf16 v[20:23], a[72:75], a[24:27], v[20:23]
    v_mfma_f32_16x16x32_bf16 v[20:23], a[76:79], a[28:31], v[20:23]
    v_mfma_f32_16x16x32_bf16 v[36:39], a[80:83], a[16:19], 0
    v_mfma_f32_16x16x32_bf16 v[36:39], a[84:87], a[20:23], v[36:39]
    v_mfma_f32_16x16x32_bf16 v[36:39], a[88:91], a[24:27], v[36:39]
    v_mfma_f32_16x16x32_bf16 v[36:39], a[92:95], a[28:31], v[36:39]
    s_waitcnt vmcnt(4)
    ds_read_b128 a[32:35], v12 offset:0
    ds_read_b128 a[36:39], v13 offset:0
    ds_read_b128 a[40:43], v14 offset:0
    ds_read_b128 a[44:47], v15 offset:0
    s_waitcnt lgkmcnt(0)
    v_mfma_f32_16x16x32_bf16 v[24:27], a[64:67], a[32:35], 0
    v_mfma_f32_16x16x32_bf16 v[24:27], a[68:71], a[36:39], v[24:27]
    v_mfma_f32_16x16x32_bf16 v[24:27], a[72:75], a[40:43], v[24:27]
    v_mfma_f32_16x16x32_bf16 v[24:27], a[76:79], a[44:47], v[24:27]
    v_mfma_f32_16x16x32_bf16 v[40:43], a[80:83], a[32:35], 0
    v_mfma_f32_16x16x32_bf16 v[40:43], a[84:87], a[36:39], v[40:43]
    v_mfma_f32_16x16x32_bf16 v[40:43], a[88:91], a[40:43], v[40:43]
    v_mfma_f32_16x16x32_bf16 v[40:43], a[92:95], a[44:47], v[40:43]
    s_nop 7
    v_max3_f32 v48, v16, v17, v18
    v_max3_f32 v48, v48, v19, v32
    v_max3_f32 v48, v48, v33, v34
    v_max_f32 v48, v48, v35
    v_max3_f32 v49, v20, v21, v22
    v_max3_f32 v49, v49, v23, v36
    v_max3_f32 v49, v49, v37, v38
    v_max_f32 v49, v49, v39
    v_max3_f32 v50, v24, v25, v26
    v_max3_f32 v50, v50, v27, v40
    v_max3_f32 v50, v50, v41, v42
    v_max_f32 v50, v50, v43
    v_mov_b32 v51, v48
    v_mov_b32 v52, v49
    v_mov_b32 v53, v50
    s_nop 1
    v_permlane32_swap_b32 v48, v51
    v_permlane32_swap_b32 v49, v52
    v_permlane32_swap_b32 v50, v53
    s_nop 1
    v_max_f32 v48, v48, v51
    v_max_f32 v49, v49, v52
    v_max_f32 v50, v50, v53
    v_mov_b32 v51, v48
    v_mov_b32 v52, v49
    v_mov_b32 v53, v50
    s_nop 1
    v_permlane16_swap_b32 v48, v51
    v_permlane16_swap_b32 v49, v52
    v_permlane16_swap_b32 v50, v53
    s_nop 1
    v_max_f32 v48, v48, v51
    v_max_f32 v49, v49, v52
    v_max_f32 v50, v50, v53
    v_sub_f32 v112, 0, v48
    v_sub_f32 v113, 0, v48
    v_sub_f32 v114, 0, v48
    v_sub_f32 v115, 0, v48
    v_sub_f32 v16, v16, v48
    v_sub_f32 v17, v17, v48
    v_sub_f32 v18, v18, v48
    v_sub_f32 v19, v19, v48
    v_sub_f32 v32, v32, v48
    v_sub_f32 v33, v33, v48
    v_sub_f32 v34, v34, v48
    v_sub_f32 v35, v35, v48
    v_sub_f32 v116, 0, v49
    v_sub_f32 v117, 0, v49
    v_sub_f32 v118, 0, v49
    v_sub_f32 v119, 0, v49
    v_sub_f32 v20, v20, v49
    v_sub_f32 v21, v21, v49
    v_sub_f32 v22, v22, v49
    v_sub_f32 v23, v23, v49
    v_sub_f32 v36, v36, v49
    v_sub_f32 v37, v37, v49
    v_sub_f32 v38, v38, v49
    v_sub_f32 v39, v39, v49
    v_sub_f32 v120, 0, v50
    v_sub_f32 v121, 0, v50
    v_sub_f32 v122, 0, v50
    v_sub_f32 v123, 0, v50
    v_sub_f32 v24, v24, v50
    v_sub_f32 v25, v25, v50
    v_sub_f32 v26, v26, v50
    v_sub_f32 v27, v27, v50
    v_sub_f32 v40, v40, v50
    v_sub_f32 v41, v41, v50
    v_sub_f32 v42, v42, v50
    v_sub_f32 v43, v43, v50
    s_cmp_lg_u32 s16, 0
    s_cbranch_scc1 M_ready
    s_mov_b32 s19, 4000
M_poll:
    buffer_load_dword v8, off, s[44:47], s52 sc1
    s_waitcnt vmcnt(0)
    v_cmp_eq_u32 vcc, 64, v8
    s_cmp_eq_u64 vcc, exec
    s_cbranch_scc1 M_ready
    s_sub_u32 s19, s19, 1
    s_cmp_eq_u32 s19, 0
    s_cbranch_scc1 M_fallback
    s_branch M_poll
M_ready:
    s_waitcnt lgkmcnt(0)
    s_barrier
    s_add_u32 s18, s18, 0x4000
    s_and_b32 s18, s18, 0xfffff
    s_xor_b32 m0, s17, 16384
    s_nop 0
    buffer_load_dwordx4 v3, s[8:11], s18 offen offset:0 sc1 lds
    buffer_load_dwordx4 v3, s[8:11], s18 offen offset:1024 sc1 lds
    buffer_load_dwordx4 v3, s[8:11], s18 offen offset:2048 sc1 lds
    buffer_load_dwordx4 v3, s[8:11], s18 offen offset:3072 sc1 lds
    s_add_u32 s18, s18, 0x4000
    s_and_b32 s18, s18, 0xfffff
    s_xor_b32 m0, s17, 32768
    s_nop 0
    buffer_load_dwordx4 v3, s[8:11], s18 offen offset:0 sc1 lds
    buffer_load_dwordx4 v3, s[8:11], s18 offen offset:1024 sc1 lds
    buffer_load_dwordx4 v3, s[8:11], s18 offen offset:2048 sc1 lds
    buffer_load_dwordx4 v3, s[8:11], s18 offen offset:3072 sc1 lds
    s_add_u32 s18, s18, 0x4000
    s_and_b32 s18, s18, 0xfffff
    s_xor_b32 m0, s17, 49152
    s_nop 0
    buffer_load_dwordx4 v3, s[8:11], s18 offen offset:0 sc1 lds
    buffer_load_dwordx4 v3, s[8:11], s18 offen offset:1024 sc1 lds
    buffer_load_dwordx4 v3, s[8:11], s18 offen offset:2048 sc1 lds
    buffer_load_dwordx4 v3, s[8:11], s18 offen offset:3072 sc1 lds
    s_waitcnt vmcnt(12)
    ds_read_b128 a[48:51], v12 offset:4096
    ds_read_b128 a[52:55], v13 offset:4096
    ds_read_b128 a[56:59], v14 offset:4096
    ds_read_b128 a[60:63], v15 offset:4096
    s_waitcnt lgkmcnt(0)
    v_mfma_f32_16x16x32_bf16 v[28:31], a[64:67], a[48:51], 0
    v_mfma_f32_16x16x32_bf16 v[28:31], a[68:71], a[52:55], v[28:31]
    v_mfma_f32_16x16x32_bf16 v[28:31], a[72:75], a[56:59], v[28:31]
    v_mfma_f32_16x16x32_bf16 v[28:31], a[76:79], a[60:63], v[28:31]
    v_mfma_f32_16x16x32_bf16 v[44:47], a[80:83], a[48:51], 0
    v_mfma_f32_16x16x32_bf16 v[44:47], a[84:87], a[52:55], v[44:47]
    v_mfma_f32_16x16x32_bf16 v[44:47], a[88:91], a[56:59], v[44:47]
    v_mfma_f32_16x16x32_bf16 v[44:47], a[92:95], a[60:63], v[44:47]
    ds_read_b128 a[64:67], v2 offset:49152
    ds_read_b128 a[68:71], v2 offset:50176
    ds_read_b128 a[72:75], v2 offset:51200
    ds_read_b128 a[76:79], v2 offset:52224
    ds_read_b128 a[80:83], v2 offset:53248
    v_mov_b32 v4, 0
    v_mov_b32 v5, 0
    v_mov_b32 v6, 0
    v_mov_b32 v7, 0
    s_barrier
    s_waitcnt lgkmcnt(1)
    s_nop 7
    v_max3_f32 v48, v28, v29, v30
    v_max3_f32 v48, v48, v31, v44
    v_max3_f32 v48, v48, v45, v46
    v_max_f32 v48, v48, v47
    v_mov_b32 v49, v48
    s_nop 1
    v_permlane32_swap_b32 v48, v49
    s_nop 1
    v_max_f32 v48, v48, v49
    v_mov_b32 v49, v48
    s_nop 1
    v_permlane16_swap_b32 v48, v49
    s_nop 1
    v_max_f32 v48, v48, v49
    v_sub_f32 v124, 0, v48
    v_sub_f32 v125, 0, v48
    v_sub_f32 v126, 0, v48
    v_sub_f32 v127, 0, v48
    v_sub_f32 v28, v28, v48
    v_sub_f32 v29, v29, v48
    v_sub_f32 v30, v30, v48
    v_sub_f32 v31, v31, v48
    v_sub_f32 v44, v44, v48
    v_sub_f32 v45, v45, v48
    v_sub_f32 v46, v46, v48
    v_sub_f32 v47, v47, v48
    s_mov_b32 s19, 16
    v_mfma_f32_16x16x32_bf16 v[48:51], a[64:67], a[0:3], v[112:115]
    s_add_u32 s18, s18, 0x4000
    v_exp_f32 v16, v16
    v_mfma_f32_16x16x32_bf16 v[48:51], a[68:71], a[4:7], v[48:51]
    s_and_b32 s18, s18, 0xfffff
    v_add_f32 v4, v4, v16
    v_mfma_f32_16x16x32_bf16 v[48:51], a[72:75], a[8:11], v[48:51]
    v_exp_f32 v17, v17
    v_mfma_f32_16x16x32_bf16 v[48:51], a[76:79], a[12:15], v[48:51]
    ds_read_b128 a[84:87], v2 offset:54272
    v_add_f32 v4, v4, v17
    s_xor_b32 m0, s17, 65536
    v_exp_f32 v18, v18
    s_nop 0
    v_add_f32 v4, v4, v18
    v_cvt_pk_bf16_f32 v80, v16, v17
    v_exp_f32 v19, v19
    s_nop 0
    v_add_f32 v4, v4, v19
    v_mfma_f32_16x16x32_bf16 v[52:55], a[64:67], a[16:19], v[116:119]
    v_exp_f32 v20, v20
    v_mfma_f32_16x16x32_bf16 v[52:55], a[68:71], a[20:23], v[52:55]
    v_add_f32 v5, v5, v20
    v_cvt_pk_bf16_f32 v81, v18, v19
    v_mfma_f32_16x16x32_bf16 v[52:55], a[72:75], a[24:27], v[52:55]
    v_exp_f32 v21, v21
    v_mfma_f32_16x16x32_bf16 v[52:55], a[76:79], a[28:31], v[52:55]
    ds_read_b128 a[88:91], v2 offset:55296
    v_add_f32 v5, v5, v21
    v_exp_f32 v22, v22
    s_nop 0
    v_add_f32 v5, v5, v22
    v_cvt_pk_bf16_f32 v84, v20, v21
    v_exp_f32 v23, v23
    s_nop 0
    v_add_f32 v5, v5, v23
    v_mfma_f32_16x16x32_bf16 v[56:59], a[64:67], a[32:35], v[120:123]
    v_exp_f32 v24, v24
    v_mfma_f32_16x16x32_bf16 v[56:59], a[68:71], a[36:39], v[56:59]
    v_add_f32 v6, v6, v24
    v_cvt_pk_bf16_f32 v85, v22, v23
    v_mfma_f32_16x16x32_bf16 v[56:59], a[72:75], a[40:43], v[56:59]
    v_exp_f32 v25, v25
    v_mfma_f32_16x16x32_bf16 v[56:59], a[76:79], a[44:47], v[56:59]
    ds_read_b128 a[92:95], v2 offset:56320
    v_add_f32 v6, v6, v25
    v_exp_f32 v26, v26
    s_nop 0
    v_add_f32 v6, v6, v26
    v_cvt_pk_bf16_f32 v88, v24, v25
    v_exp_f32 v27, v27
    s_nop 0
    v_add_f32 v6, v6, v27
    v_mfma_f32_16x16x32_bf16 v[60:63], a[64:67], a[48:51], v[124:127]
    v_exp_f32 v28, v28
    v_mfma_f32_16x16x32_bf16 v[60:63], a[68:71], a[52:55], v[60:63]
    ds_read_b128 a[64:67], v1 offset:0
    v_cvt_pk_bf16_f32 v89, v26, v27
    v_mfma_f32_16x16x32_bf16 v[60:63], a[72:75], a[56:59], v[60:63]
    v_exp_f32 v29, v29
    v_mfma_f32_16x16x32_bf16 v[60:63], a[76:79], a[60:63], v[60:63]
    buffer_load_dwordx4 v3, s[8:11], s18 offen offset:0 sc1 lds
    v_exp_f32 v30, v30
    v_cvt_pk_bf16_f32 v92, v28, v29
    s_waitcnt lgkmcnt(1)
    v_exp_f32 v31, v31
    buffer_load_dwordx4 v3, s[8:11], s18 offen offset:1024 sc1 lds
    v_mfma_f32_16x16x32_bf16 v[64:67], a[80:83], a[0:3], v[112:115]
    v_exp_f32 v32, v32
    v_mfma_f32_16x16x32_bf16 v[64:67], a[84:87], a[4:7], v[64:67]
    v_add_f32 v4, v4, v32
    v_cvt_pk_bf16_f32 v93, v30, v31
    v_mfma_f32_16x16x32_bf16 v[64:67], a[88:91], a[8:11], v[64:67]
    v_exp_f32 v33, v33
    v_mfma_f32_16x16x32_bf16 v[64:67], a[92:95], a[12:15], v[64:67]
    ds_read_b128 a[68:71], v1 offset:1024
    v_add_f32 v4, v4, v33
    v_exp_f32 v34, v34
    s_nop 0
    v_add_f32 v4, v4, v34
    v_cvt_pk_bf16_f32 v82, v32, v33
    v_exp_f32 v35, v35
    s_nop 0
    v_add_f32 v4, v4, v35
    v_mfma_f32_16x16x32_bf16 v[68:71], a[80:83], a[16:19], v[116:119]
    v_exp_f32 v36, v36
    v_mfma_f32_16x16x32_bf16 v[68:71], a[84:87], a[20:23], v[68:71]
    v_add_f32 v5, v5, v36
    v_cvt_pk_bf16_f32 v83, v34, v35
    v_mfma_f32_16x16x32_bf16 v[68:71], a[88:91], a[24:27], v[68:71]
    v_exp_f32 v37, v37
    v_mfma_f32_16x16x32_bf16 v[68:71], a[92:95], a[28:31], v[68:71]
    ds_read_b128 a[72:75], v1 offset:2048
    v_add_f32 v5, v5, v37
    v_exp_f32 v38, v38
    s_nop 0
    v_add_f32 v5, v5, v38
    v_cvt_pk_bf16_f32 v86, v36, v37
    v_exp_f32 v39, v39
    s_nop 0
    v_add_f32 v5, v5, v39
    v_mfma_f32_16x16x32_bf16 v[72:75], a[80:83], a[32:35], v[120:123]
    v_exp_f32 v40, v40
    v_mfma_f32_16x16x32_bf16 v[72:75], a[84:87], a[36:39], v[72:75]
    v_add_f32 v6, v6, v40
    v_cvt_pk_bf16_f32 v87, v38, v39
    v_mfma_f32_16x16x32_bf16 v[72:75], a[88:91], a[40:43], v[72:75]
    v_exp_f32 v41, v41
    v_mfma_f32_16x16x32_bf16 v[72:75], a[92:95], a[44:47], v[72:75]
    ds_read_b128 a[76:79], v1 offset:3072
    v_add_f32 v6, v6, v41
    v_exp_f32 v42, v42
    s_nop 0
    v_add_f32 v6, v6, v42
    v_cvt_pk_bf16_f32 v90, v40, v41
    v_exp_f32 v43, v43
    ds_read_b128 a[96:99], v1 offset:8192
    v_add_f32 v6, v6, v43
    v_mfma_f32_16x16x32_bf16 v[76:79], a[80:83], a[48:51], v[124:127]
    v_exp_f32 v44, v44
    v_mfma_f32_16x16x32_bf16 v[76:79], a[84:87], a[52:55], v[76:79]
    ds_read_b128 a[80:83], v1 offset:4096
    v_cvt_pk_bf16_f32 v91, v42, v43
    v_mfma_f32_16x16x32_bf16 v[76:79], a[88:91], a[56:59], v[76:79]
    v_exp_f32 v45, v45
    v_mfma_f32_16x16x32_bf16 v[76:79], a[92:95], a[60:63], v[76:79]
    buffer_load_dwordx4 v3, s[8:11], s18 offen offset:2048 sc1 lds
    v_exp_f32 v46, v46
    ds_read_b128 a[100:103], v1 offset:9216
    v_cvt_pk_bf16_f32 v94, v44, v45
    s_waitcnt lgkmcnt(3)
    v_exp_f32 v47, v47
    buffer_load_dwordx4 v3, s[8:11], s18 offen offset:3072 sc1 lds
    s_nop 7
    s_branch M_pos1
.p2align 6
M_pos3:
    v_mfma_f32_16x16x32_bf16 v[16:19], a[64:67], a[0:3], v[112:115]
    s_add_u32 s18, s18, 0x4000
    v_exp_f32 v48, v48
    v_mfma_f32_16x16x32_bf16 v[16:19], a[68:71], a[4:7], v[16:19]
    s_and_b32 s18, s18, 0xfffff
    v_add_f32 v4, v4, v48
    v_cvt_pk_bf16_f32 v95, v46, v47
    v_mfma_f32_16x16x32_bf16 v[16:19], a[72:75], a[8:11], v[16:19]
    s_waitcnt lgkmcnt(2)
    v_exp_f32 v49, v49
    v_mfma_f32_16x16x32_bf16 v[16:19], a[76:79], a[12:15], v[16:19]
    ds_read_b128 a[84:87], v2 offset:37888
    v_add_f32 v4, v4, v49
    v_mfma_f32_16x16x32_bf16 v[128:131], v[80:83], a[96:99], v[128:131]
    s_xor_b32 m0, s17, 49152
    v_exp_f32 v50, v50
    v_mfma_f32_16x16x32_bf16 v[132:135], v[84:87], a[96:99], v[132:135]
    v_add_f32 v4, v4, v50
    v_cvt_pk_bf16_f32 v96, v48, v49
    v_mfma_f32_16x16x32_bf16 v[136:139], v[88:91], a[96:99], v[136:139]
    v_exp_f32 v51, v51
    v_mfma_f32_16x16x32_bf16 v[140:143], v[92:95], a[96:99], v[140:143]
    ds_read_b128 a[104:107], v2 offset:43008
    v_add_f32 v4, v4, v51
    v_mfma_f32_16x16x32_bf16 v[20:23], a[64:67], a[16:19], v[116:119]
    v_exp_f32 v52, v52
    v_mfma_f32_16x16x32_bf16 v[20:23], a[68:71], a[20:23], v[20:23]
    v_add_f32 v5, v5, v52
    v_cvt_pk_bf16_f32 v97, v50, v51
    v_mfma_f32_16x16x32_bf16 v[20:23], a[72:75], a[24:27], v[20:23]
    s_waitcnt lgkmcnt(2)
    v_exp_f32 v53, v53
    v_mfma_f32_16x16x32_bf16 v[20:23], a[76:79], a[28:31], v[20:23]
    ds_read_b128 a[88:91], v2 offset:38912
    v_add_f32 v5, v5, v53
    v_mfma_f32_16x16x32_bf16 v[144:147], v[80:83], a[100:103], v[144:147]
    v_exp_f32 v54, v54
    v_mfma_f32_16x16x32_bf16 v[148:151], v[84:87], a[100:103], v[148:151]
    v_add_f32 v5, v5, v54
    v_cvt_pk_bf16_f32 v100, v52, v53
    v_mfma_f32_16x16x32_bf16 v[152:155], v[88:91], a[100:103], v[152:155]
    v_exp_f32 v55, v55
    v_mfma_f32_16x16x32_bf16 v[156:159], v[92:95], a[100:103], v[156:159]
    ds_read_b128 a[108:111], v2 offset:44032
    v_add_f32 v5, v5, v55
    v_mfma_f32_16x16x32_bf16 v[24:27], a[64:67], a[32:35], v[120:123]
    v_exp_f32 v56, v56
    v_mfma_f32_16x16x32_bf16 v[24:27], a[68:71], a[36:39], v[24:27]
    v_add_f32 v6, v6, v56
    v_cvt_pk_bf16_f32 v101, v54, v55
    v_mfma_f32_16x16x32_bf16 v[24:27], a[72:75], a[40:43], v[24:27]
    s_waitcnt lgkmcnt(2)
    v_exp_f32 v57, v57
    v_mfma_f32_16x16x32_bf16 v[24:27], a[76:79], a[44:47], v[24:27]
    ds_read_b128 a[92:95], v2 offset:39936
    v_add_f32 v6, v6, v57
    v_mfma_f32_16x16x32_bf16 v[160:163], v[80:83], a[104:107], v[160:163]
    v_exp_f32 v58, v58
    v_mfma_f32_16x16x32_bf16 v[164:167], v[84:87], a[104:107], v[164:167]
    s_waitcnt vmcnt(8)
    v_add_f32 v6, v6, v58
    v_cvt_pk_bf16_f32 v104, v56, v57
    v_mfma_f32_16x16x32_bf16 v[168:171], v[88:91], a[104:107], v[168:171]
    v_exp_f32 v59, v59
    v_mfma_f32_16x16x32_bf16 v[172:175], v[92:95], a[104:107], v[172:175]
    ds_read_b128 a[96:99], v2 offset:45056
    v_add_f32 v6, v6, v59
    v_mfma_f32_16x16x32_bf16 a[128:131], a[112:115], v[92:95], a[128:131]
    s_barrier
    v_mfma_f32_16x16x32_bf16 v[28:31], a[64:67], a[48:51], v[124:127]
    v_exp_f32 v60, v60
    v_mfma_f32_16x16x32_bf16 v[28:31], a[68:71], a[52:55], v[28:31]
    ds_read_b128 a[64:67], v2 offset:49152
    v_cvt_pk_bf16_f32 v105, v58, v59
    v_mfma_f32_16x16x32_bf16 v[28:31], a[72:75], a[56:59], v[28:31]
    s_waitcnt lgkmcnt(3)
    v_exp_f32 v61, v61
    v_mfma_f32_16x16x32_bf16 v[28:31], a[76:79], a[60:63], v[28:31]
    buffer_load_dwordx4 v3, s[8:11], s18 offen offset:0 sc1 lds
    v_mfma_f32_16x16x32_bf16 v[176:179], v[80:83], a[108:111], v[176:179]
    v_exp_f32 v62, v62
    v_mfma_f32_16x16x32_bf16 v[180:183], v[84:87], a[108:111], v[180:183]
    ds_read_b128 a[100:103], v2 offset:46080
    v_cvt_pk_bf16_f32 v108, v60, v61
    v_mfma_f32_16x16x32_bf16 v[184:187], v[88:91], a[108:111], v[184:187]
    s_waitcnt lgkmcnt(3)
    v_exp_f32 v63, v63
    v_mfma_f32_16x16x32_bf16 v[188:191], v[92:95], a[108:111], v[188:191]
    buffer_load_dwordx4 v3, s[8:11], s18 offen offset:1024 sc1 lds
    v_mfma_f32_16x16x32_bf16 v[32:35], a[80:83], a[0:3], v[112:115]
    v_exp_f32 v64, v64
    v_mfma_f32_16x16x32_bf16 v[32:35], a[84:87], a[4:7], v[32:35]
    v_add_f32 v4, v4, v64
    v_cvt_pk_bf16_f32 v109, v62, v63
    v_mfma_f32_16x16x32_bf16 v[32:35], a[88:91], a[8:11], v[32:35]
    s_waitcnt lgkmcnt(2)
    v_exp_f32 v65, v65
    v_mfma_f32_16x16x32_bf16 v[32:35], a[92:95], a[12:15], v[32:35]
    ds_read_b128 a[68:71], v2 offset:50176
    v_add_f32 v4, v4, v65
    v_mfma_f32_16x16x32_bf16 v[192:195], v[80:83], a[96:99], v[192:195]
    v_exp_f32 v66, v66
    v_mfma_f32_16x16x32_bf16 v[196:199], v[84:87], a[96:99], v[196:199]
    v_add_f32 v4, v4, v66
    v_cvt_pk_bf16_f32 v98, v64, v65
    v_mfma_f32_16x16x32_bf16 v[200:203], v[88:91], a[96:99], v[200:203]
    v_exp_f32 v67, v67
    v_mfma_f32_16x16x32_bf16 v[204:207], v[92:95], a[96:99], v[204:207]
    ds_read_b128 a[104:107], v2 offset:47104
    v_add_f32 v4, v4, v67
    v_mfma_f32_16x16x32_bf16 v[36:39], a[80:83], a[16:19], v[116:119]
    v_exp_f32 v68, v68
    v_mfma_f32_16x16x32_bf16 v[36:39], a[84:87], a[20:23], v[36:39]
    v_add_f32 v5, v5, v68
    v_cvt_pk_bf16_f32 v99, v66, v67
    v_mfma_f32_16x16x32_bf16 v[36:39], a[88:91], a[24:27], v[36:39]
    s_waitcnt lgkmcnt(2)
    v_exp_f32 v69, v69
    v_mfma_f32_16x16x32_bf16 v[36:39], a[92:95], a[28:31], v[36:39]
    ds_read_b128 a[72:75], v2 offset:51200
    v_add_f32 v5, v5, v69
    v_mfma_f32_16x16x32_bf16 v[208:211], v[80:83], a[100:103], v[208:211]
    v_exp_f32 v70, v70
    v_mfma_f32_16x16x32_bf16 v[212:215], v[84:87], a[100:103], v[212:215]
    v_add_f32 v5, v5, v70
    v_cvt_pk_bf16_f32 v102, v68, v69
    v_mfma_f32_16x16x32_bf16 v[216:219], v[88:91], a[100:103], v[216:219]
    v_exp_f32 v71, v71
    v_mfma_f32_16x16x32_bf16 v[220:223], v[92:95], a[100:103], v[220:223]
    ds_read_b128 a[108:111], v2 offset:48128
    v_add_f32 v5, v5, v71
    v_mfma_f32_16x16x32_bf16 v[40:43], a[80:83], a[32:35], v[120:123]
    v_exp_f32 v72, v72
    v_mfma_f32_16x16x32_bf16 v[40:43], a[84:87], a[36:39], v[40:43]
    v_add_f32 v6, v6, v72
    v_cvt_pk_bf16_f32 v103, v70, v71
    v_mfma_f32_16x16x32_bf16 v[40:43], a[88:91], a[40:43], v[40:43]
    s_waitcnt lgkmcnt(2)
    v_exp_f32 v73, v73
    v_mfma_f32_16x16x32_bf16 v[40:43], a[92:95], a[44:47], v[40:43]
    ds_read_b128 a[76:79], v2 offset:52224
    v_add_f32 v6, v6, v73
    v_mfma_f32_16x16x32_bf16 v[224:227], v[80:83], a[104:107], v[224:227]
    v_exp_f32 v74, v74
    v_mfma_f32_16x16x32_bf16 v[228:231], v[84:87], a[104:107], v[228:231]
    v_add_f32 v6, v6, v74
    v_cvt_pk_bf16_f32 v106, v72, v73
    v_mfma_f32_16x16x32_bf16 v[232:235], v[88:91], a[104:107], v[232:235]
    v_exp_f32 v75, v75
    v_mfma_f32_16x16x32_bf16 v[236:239], v[92:95], a[104:107], v[236:239]
    ds_read_b128 a[96:99], v2 offset:57344
    v_add_f32 v6, v6, v75
    v_mfma_f32_16x16x32_bf16 v[44:47], a[80:83], a[48:51], v[124:127]
    v_exp_f32 v76, v76
    v_mfma_f32_16x16x32_bf16 v[44:47], a[84:87], a[52:55], v[44:47]
    ds_read_b128 a[80:83], v2 offset:53248
    v_cvt_pk_bf16_f32 v107, v74, v75
    v_mfma_f32_16x16x32_bf16 v[44:47], a[88:91], a[56:59], v[44:47]
    s_waitcnt lgkmcnt(3)
    v_exp_f32 v77, v77
    v_mfma_f32_16x16x32_bf16 v[44:47], a[92:95], a[60:63], v[44:47]
    buffer_load_dwordx4 v3, s[8:11], s18 offen offset:2048 sc1 lds
    v_mfma_f32_16x16x32_bf16 v[240:243], v[80:83], a[108:111], v[240:243]
    v_exp_f32 v78, v78
    v_mfma_f32_16x16x32_bf16 v[244:247], v[84:87], a[108:111], v[244:247]
    ds_read_b128 a[100:103], v2 offset:58368
    v_cvt_pk_bf16_f32 v110, v76, v77
    v_mfma_f32_16x16x32_bf16 v[248:251], v[88:91], a[108:111], v[248:251]
    s_waitcnt lgkmcnt(3)
    v_exp_f32 v79, v79
    v_mfma_f32_16x16x32_bf16 v[252:255], v[92:95], a[108:111], v[252:255]
    buffer_load_dwordx4 v3, s[8:11], s18 offen offset:3072 sc1 lds
M_pos0:
    v_mfma_f32_16x16x32_bf16 v[48:51], a[64:67], a[0:3], v[112:115]
    s_add_u32 s18, s18, 0x4000
    v_exp_f32 v16, v16
    v_mfma_f32_16x16x32_bf16 v[48:51], a[68:71], a[4:7], v[48:51]
    s_and_b32 s18, s18, 0xfffff
    v_add_f32 v4, v4, v16
    v_cvt_pk_bf16_f32 v111, v78, v79
    v_mfma_f32_16x16x32_bf16 v[48:51], a[72:75], a[8:11], v[48:51]
    s_waitcnt lgkmcnt(2)
    v_exp_f32 v17, v17
    v_mfma_f32_16x16x32_bf16 v[48:51], a[76:79], a[12:15], v[48:51]
    ds_read_b128 a[84:87], v2 offset:54272
    v_add_f32 v4, v4, v17
    v_mfma_f32_16x16x32_bf16 v[128:131], v[96:99], a[96:99], v[128:131]
    s_xor_b32 m0, s17, 65536
    v_exp_f32 v18, v18
    v_mfma_f32_16x16x32_bf16 v[132:135], v[100:103], a[96:99], v[132:135]
    v_add_f32 v4, v4, v18
    v_cvt_pk_bf16_f32 v80, v16, v17
    v_mfma_f32_16x16x32_bf16 v[136:139], v[104:107], a[96:99], v[136:139]
    v_exp_f32 v19, v19
    v_mfma_f32_16x16x32_bf16 v[140:143], v[108:111], a[96:99], v[140:143]
    ds_read_b128 a[104:107], v2 offset:59392
    v_add_f32 v4, v4, v19
    v_mfma_f32_16x16x32_bf16 v[52:55], a[64:67], a[16:19], v[116:119]
    v_exp_f32 v20, v20
    v_mfma_f32_16x16x32_bf16 v[52:55], a[68:71], a[20:23], v[52:55]
    v_add_f32 v5, v5, v20
    v_cvt_pk_bf16_f32 v81, v18, v19
    v_mfma_f32_16x16x32_bf16 v[52:55], a[72:75], a[24:27], v[52:55]
    s_waitcnt lgkmcnt(2)
    v_exp_f32 v21, v21
    v_mfma_f32_16x16x32_bf16 v[52:55], a[76:79], a[28:31], v[52:55]
    ds_read_b128 a[88:91], v2 offset:55296
    v_add_f32 v5, v5, v21
    v_mfma_f32_16x16x32_bf16 v[144:147], v[96:99], a[100:103], v[144:147]
    v_exp_f32 v22, v22
    v_mfma_f32_16x16x32_bf16 v[148:151], v[100:103], a[100:103], v[148:151]
    v_add_f32 v5, v5, v22
    v_cvt_pk_bf16_f32 v84, v20, v21
    v_mfma_f32_16x16x32_bf16 v[152:155], v[104:107], a[100:103], v[152:155]
    v_exp_f32 v23, v23
    v_mfma_f32_16x16x32_bf16 v[156:159], v[108:111], a[100:103], v[156:159]
    ds_read_b128 a[108:111], v2 offset:60416
    v_add_f32 v5, v5, v23
    v_mfma_f32_16x16x32_bf16 v[56:59], a[64:67], a[32:35], v[120:123]
    v_exp_f32 v24, v24
    v_mfma_f32_16x16x32_bf16 v[56:59], a[68:71], a[36:39], v[56:59]
    v_add_f32 v6, v6, v24
    v_cvt_pk_bf16_f32 v85, v22, v23
    v_mfma_f32_16x16x32_bf16 v[56:59], a[72:75], a[40:43], v[56:59]
    s_waitcnt lgkmcnt(2)
    v_exp_f32 v25, v25
    v_mfma_f32_16x16x32_bf16 v[56:59], a[76:79], a[44:47], v[56:59]
    ds_read_b128 a[92:95], v2 offset:56320
    v_add_f32 v6, v6, v25
    v_mfma_f32_16x16x32_bf16 v[160:163], v[96:99], a[104:107], v[160:163]
    v_exp_f32 v26, v26
    v_mfma_f32_16x16x32_bf16 v[164:167], v[100:103], a[104:107], v[164:167]
    v_add_f32 v6, v6, v26
    v_cvt_pk_bf16_f32 v88, v24, v25
    v_mfma_f32_16x16x32_bf16 v[168:171], v[104:107], a[104:107], v[168:171]
    v_exp_f32 v27, v27
    v_mfma_f32_16x16x32_bf16 v[172:175], v[108:111], a[104:107], v[172:175]
    ds_read_b128 a[96:99], v2 offset:61440
    v_add_f32 v6, v6, v27
    v_mfma_f32_16x16x32_bf16 a[128:131], a[112:115], v[108:111], a[128:131]
    v_mfma_f32_16x16x32_bf16 v[60:63], a[64:67], a[48:51], v[124:127]
    v_exp_f32 v28, v28
    v_mfma_f32_16x16x32_bf16 v[60:63], a[68:71], a[52:55], v[60:63]
    ds_read_b128 a[64:67], v1 offset:0
    v_cvt_pk_bf16_f32 v89, v26, v27
    v_mfma_f32_16x16x32_bf16 v[60:63], a[72:75], a[56:59], v[60:63]
    s_waitcnt lgkmcnt(3)
    v_exp_f32 v29, v29
    v_mfma_f32_16x16x32_bf16 v[60:63], a[76:79], a[60:63], v[60:63]
    buffer_load_dwordx4 v3, s[8:11], s18 offen offset:0 sc1 lds
    v_mfma_f32_16x16x32_bf16 v[176:179], v[96:99], a[108:111], v[176:179]
    v_exp_f32 v30, v30
    v_mfma_f32_16x16x32_bf16 v[180:183], v[100:103], a[108:111], v[180:183]
    ds_read_b128 a[100:103], v2 offset:62464
    v_cvt_pk_bf16_f32 v92, v28, v29
    v_mfma_f32_16x16x32_bf16 v[184:187], v[104:107], a[108:111], v[184:187]
    s_waitcnt lgkmcnt(3)
    v_exp_f32 v31, v31
    v_mfma_f32_16x16x32_bf16 v[188:191], v[108:111], a[108:111], v[188:191]
    buffer_load_dwordx4 v3, s[8:11], s18 offen offset:1024 sc1 lds
    v_mfma_f32_16x16x32_bf16 v[64:67], a[80:83], a[0:3], v[112:115]
    v_exp_f32 v32, v32
    v_mfma_f32_16x16x32_bf16 v[64:67], a[84:87], a[4:7], v[64:67]
    v_add_f32 v4, v4, v32
    v_cvt_pk_bf16_f32 v93, v30, v31
    v_mfma_f32_16x16x32_bf16 v[64:67], a[88:91], a[8:11], v[64:67]
    s_waitcnt lgkmcnt(2)
    v_exp_f32 v33, v33
    v_mfma_f32_16x16x32_bf16 v[64:67], a[92:95], a[12:15], v[64:67]
    ds_read_b128 a[68:71], v1 offset:1024
    v_add_f32 v4, v4, v33
    v_mfma_f32_16x16x32_bf16 v[192:195], v[96:99], a[96:99], v[192:195]
    v_exp_f32 v34, v34
    v_mfma_f32_16x16x32_bf16 v[196:199], v[100:103], a[96:99], v[196:199]
    v_add_f32 v4, v4, v34
    v_cvt_pk_bf16_f32 v82, v32, v33
    v_mfma_f32_16x16x32_bf16 v[200:203], v[104:107], a[96:99], v[200:203]
    v_exp_f32 v35, v35
    v_mfma_f32_16x16x32_bf16 v[204:207], v[108:111], a[96:99], v[204:207]
    ds_read_b128 a[104:107], v2 offset:63488
    v_add_f32 v4, v4, v35
    v_mfma_f32_16x16x32_bf16 v[68:71], a[80:83], a[16:19], v[116:119]
    v_exp_f32 v36, v36
    v_mfma_f32_16x16x32_bf16 v[68:71], a[84:87], a[20:23], v[68:71]
    v_add_f32 v5, v5, v36
    v_cvt_pk_bf16_f32 v83, v34, v35
    v_mfma_f32_16x16x32_bf16 v[68:71], a[88:91], a[24:27], v[68:71]
    s_waitcnt lgkmcnt(2)
    v_exp_f32 v37, v37
    v_mfma_f32_16x16x32_bf16 v[68:71], a[92:95], a[28:31], v[68:71]
    ds_read_b128 a[72:75], v1 offset:2048
    v_add_f32 v5, v5, v37
    v_mfma_f32_16x16x32_bf16 v[208:211], v[96:99], a[100:103], v[208:211]
    v_exp_f32 v38, v38
    v_mfma_f32_16x16x32_bf16 v[212:215], v[100:103], a[100:103], v[212:215]
    v_add_f32 v5, v5, v38
    v_cvt_pk_bf16_f32 v86, v36, v37
    v_mfma_f32_16x16x32_bf16 v[216:219], v[104:107], a[100:103], v[216:219]
    v_exp_f32 v39, v39
    v_mfma_f32_16x16x32_bf16 v[220:223], v[108:111], a[100:103], v[220:223]
    ds_read_b128 a[108:111], v2 offset:64512
    v_add_f32 v5, v5, v39
    v_mfma_f32_16x16x32_bf16 v[72:75], a[80:83], a[32:35], v[120:123]
    v_exp_f32 v40, v40
    v_mfma_f32_16x16x32_bf16 v[72:75], a[84:87], a[36:39], v[72:75]
    v_add_f32 v6, v6, v40
    v_cvt_pk_bf16_f32 v87, v38, v39
    v_mfma_f32_16x16x32_bf16 v[72:75], a[88:91], a[40:43], v[72:75]
    s_waitcnt lgkmcnt(2)
    v_exp_f32 v41, v41
    v_mfma_f32_16x16x32_bf16 v[72:75], a[92:95], a[44:47], v[72:75]
    ds_read_b128 a[76:79], v1 offset:3072
    v_add_f32 v6, v6, v41
    v_mfma_f32_16x16x32_bf16 v[224:227], v[96:99], a[104:107], v[224:227]
    v_exp_f32 v42, v42
    v_mfma_f32_16x16x32_bf16 v[228:231], v[100:103], a[104:107], v[228:231]
    v_add_f32 v6, v6, v42
    v_cvt_pk_bf16_f32 v90, v40, v41
    v_mfma_f32_16x16x32_bf16 v[232:235], v[104:107], a[104:107], v[232:235]
    v_exp_f32 v43, v43
    v_mfma_f32_16x16x32_bf16 v[236:239], v[108:111], a[104:107], v[236:239]
    ds_read_b128 a[96:99], v1 offset:8192
    v_add_f32 v6, v6, v43
    v_mfma_f32_16x16x32_bf16 v[76:79], a[80:83], a[48:51], v[124:127]
    v_exp_f32 v44, v44
    v_mfma_f32_16x16x32_bf16 v[76:79], a[84:87], a[52:55], v[76:79]
    ds_read_b128 a[80:83], v1 offset:4096
    v_cvt_pk_bf16_f32 v91, v42, v43
    v_mfma_f32_16x16x32_bf16 v[76:79], a[88:91], a[56:59], v[76:79]
    s_waitcnt lgkmcnt(3)
    v_exp_f32 v45, v45
    v_mfma_f32_16x16x32_bf16 v[76:79], a[92:95], a[60:63], v[76:79]
    buffer_load_dwordx4 v3, s[8:11], s18 offen offset:2048 sc1 lds
    v_mfma_f32_16x16x32_bf16 v[240:243], v[96:99], a[108:111], v[240:243]
    v_exp_f32 v46, v46
    v_mfma_f32_16x16x32_bf16 v[244:247], v[100:103], a[108:111], v[244:247]
    ds_read_b128 a[100:103], v1 offset:9216
    v_cvt_pk_bf16_f32 v94, v44, v45
    v_mfma_f32_16x16x32_bf16 v[248:251], v[104:107], a[108:111], v[248:251]
    s_waitcnt lgkmcnt(3)
    v_exp_f32 v47, v47
    v_mfma_f32_16x16x32_bf16 v[252:255], v[108:111], a[108:111], v[252:255]
    buffer_load_dwordx4 v3, s[8:11], s18 offen offset:3072 sc1 lds
M_pos1:
    v_mfma_f32_16x16x32_bf16 v[16:19], a[64:67], a[0:3], v[112:115]
    s_add_u32 s18, s18, 0x4000
    v_exp_f32 v48, v48
    v_mfma_f32_16x16x32_bf16 v[16:19], a[68:71], a[4:7], v[16:19]
    s_and_b32 s18, s18, 0xfffff
    v_add_f32 v4, v4, v48
    v_cvt_pk_bf16_f32 v95, v46, v47
    v_mfma_f32_16x16x32_bf16 v[16:19], a[72:75], a[8:11], v[16:19]
    s_waitcnt lgkmcnt(2)
    v_exp_f32 v49, v49
    v_mfma_f32_16x16x32_bf16 v[16:19], a[76:79], a[12:15], v[16:19]
    ds_read_b128 a[84:87], v1 offset:5120
    v_add_f32 v4, v4, v49
    v_mfma_f32_16x16x32_bf16 v[128:131], v[80:83], a[96:99], v[128:131]
    s_xor_b32 m0, s17, 81920
    v_exp_f32 v50, v50
    v_mfma_f32_16x16x32_bf16 v[132:135], v[84:87], a[96:99], v[132:135]
    v_add_f32 v4, v4, v50
    v_cvt_pk_bf16_f32 v96, v48, v49
    v_mfma_f32_16x16x32_bf16 v[136:139], v[88:91], a[96:99], v[136:139]
    v_exp_f32 v51, v51
    v_mfma_f32_16x16x32_bf16 v[140:143], v[92:95], a[96:99], v[140:143]
    ds_read_b128 a[104:107], v1 offset:10240
    v_add_f32 v4, v4, v51
    v_mfma_f32_16x16x32_bf16 v[20:23], a[64:67], a[16:19], v[116:119]
    v_exp_f32 v52, v52
    v_mfma_f32_16x16x32_bf16 v[20:23], a[68:71], a[20:23], v[20:23]
    v_add_f32 v5, v5, v52
    v_cvt_pk_bf16_f32 v97, v50, v51
    v_mfma_f32_16x16x32_bf16 v[20:23], a[72:75], a[24:27], v[20:23]
    s_waitcnt lgkmcnt(2)
    v_exp_f32 v53, v53
    v_mfma_f32_16x16x32_bf16 v[20:23], a[76:79], a[28:31], v[20:23]
    ds_read_b128 a[88:91], v1 offset:6144
    v_add_f32 v5, v5, v53
    v_mfma_f32_16x16x32_bf16 v[144:147], v[80:83], a[100:103], v[144:147]
    v_exp_f32 v54, v54
    v_mfma_f32_16x16x32_bf16 v[148:151], v[84:87], a[100:103], v[148:151]
    v_add_f32 v5, v5, v54
    v_cvt_pk_bf16_f32 v100, v52, v53
    v_mfma_f32_16x16x32_bf16 v[152:155], v[88:91], a[100:103], v[152:155]
    v_exp_f32 v55, v55
    v_mfma_f32_16x16x32_bf16 v[156:159], v[92:95], a[100:103], v[156:159]
    ds_read_b128 a[108:111], v1 offset:11264
    v_add_f32 v5, v5, v55
    v_mfma_f32_16x16x32_bf16 v[24:27], a[64:67], a[32:35], v[120:123]
    v_exp_f32 v56, v56
    v_mfma_f32_16x16x32_bf16 v[24:27], a[68:71], a[36:39], v[24:27]
    v_add_f32 v6, v6, v56
    v_cvt_pk_bf16_f32 v101, v54, v55
    v_mfma_f32_16x16x32_bf16 v[24:27], a[72:75], a[40:43], v[24:27]
    s_waitcnt lgkmcnt(2)
    v_exp_f32 v57, v57
    v_mfma_f32_16x16x32_bf16 v[24:27], a[76:79], a[44:47], v[24:27]
    ds_read_b128 a[92:95], v1 offset:7168
    v_add_f32 v6, v6, v57
    v_mfma_f32_16x16x32_bf16 v[160:163], v[80:83], a[104:107], v[160:163]
    v_exp_f32 v58, v58
    v_mfma_f32_16x16x32_bf16 v[164:167], v[84:87], a[104:107], v[164:167]
    s_waitcnt vmcnt(8)
    v_add_f32 v6, v6, v58
    v_cvt_pk_bf16_f32 v104, v56, v57
    v_mfma_f32_16x16x32_bf16 v[168:171], v[88:91], a[104:107], v[168:171]
    v_exp_f32 v59, v59
    v_mfma_f32_16x16x32_bf16 v[172:175], v[92:95], a[104:107], v[172:175]
    ds_read_b128 a[96:99], v1 offset:12288
    v_add_f32 v6, v6, v59
    v_mfma_f32_16x16x32_bf16 a[128:131], a[112:115], v[92:95], a[128:131]
    s_barrier
    v_mfma_f32_16x16x32_bf16 v[28:31], a[64:67], a[48:51], v[124:127]
    v_exp_f32 v60, v60
    v_mfma_f32_16x16x32_bf16 v[28:31], a[68:71], a[52:55], v[28:31]
    ds_read_b128 a[64:67], v1 offset:16384
    v_cvt_pk_bf16_f32 v105, v58, v59
    v_mfma_f32_16x16x32_bf16 v[28:31], a[72:75], a[56:59], v[28:31]
    s_waitcnt lgkmcnt(3)
    v_exp_f32 v61, v61
    v_mfma_f32_16x16x32_bf16 v[28:31], a[76:79], a[60:63], v[28:31]
    buffer_load_dwordx4 v3, s[8:11], s18 offen offset:0 sc1 lds
    v_mfma_f32_16x16x32_bf16 v[176:179], v[80:83], a[108:111], v[176:179]
    v_exp_f32 v62, v62
    v_mfma_f32_16x16x32_bf16 v[180:183], v[84:87], a[108:111], v[180:183]
    ds_read_b128 a[100:103], v1 offset:13312
    v_cvt_pk_bf16_f32 v108, v60, v61
    v_mfma_f32_16x16x32_bf16 v[184:187], v[88:91], a[108:111], v[184:187]
    s_waitcnt lgkmcnt(3)
    v_exp_f32 v63, v63
    v_mfma_f32_16x16x32_bf16 v[188:191], v[92:95], a[108:111], v[188:191]
    buffer_load_dwordx4 v3, s[8:11], s18 offen offset:1024 sc1 lds
    v_mfma_f32_16x16x32_bf16 v[32:35], a[80:83], a[0:3], v[112:115]
    v_exp_f32 v64, v64
    v_mfma_f32_16x16x32_bf16 v[32:35], a[84:87], a[4:7], v[32:35]
    v_add_f32 v4, v4, v64
    v_cvt_pk_bf16_f32 v109, v62, v63
    v_mfma_f32_16x16x32_bf16 v[32:35], a[88:91], a[8:11], v[32:35]
    s_waitcnt lgkmcnt(2)
    v_exp_f32 v65, v65
    v_mfma_f32_16x16x32_bf16 v[32:35], a[92:95], a[12:15], v[32:35]
    ds_read_b128 a[68:71], v1 offset:17408
    v_add_f32 v4, v4, v65
    v_mfma_f32_16x16x32_bf16 v[192:195], v[80:83], a[96:99], v[192:195]
    v_exp_f32 v66, v66
    v_mfma_f32_16x16x32_bf16 v[196:199], v[84:87], a[96:99], v[196:199]
    v_add_f32 v4, v4, v66
    v_cvt_pk_bf16_f32 v98, v64, v65
    v_mfma_f32_16x16x32_bf16 v[200:203], v[88:91], a[96:99], v[200:203]
    v_exp_f32 v67, v67
    v_mfma_f32_16x16x32_bf16 v[204:207], v[92:95], a[96:99], v[204:207]
    ds_read_b128 a[104:107], v1 offset:14336
    v_add_f32 v4, v4, v67
    v_mfma_f32_16x16x32_bf16 v[36:39], a[80:83], a[16:19], v[116:119]
    v_exp_f32 v68, v68
    v_mfma_f32_16x16x32_bf16 v[36:39], a[84:87], a[20:23], v[36:39]
    v_add_f32 v5, v5, v68
    v_cvt_pk_bf16_f32 v99, v66, v67
    v_mfma_f32_16x16x32_bf16 v[36:39], a[88:91], a[24:27], v[36:39]
    s_waitcnt lgkmcnt(2)
    v_exp_f32 v69, v69
    v_mfma_f32_16x16x32_bf16 v[36:39], a[92:95], a[28:31], v[36:39]
    ds_read_b128 a[72:75], v1 offset:18432
    v_add_f32 v5, v5, v69
    v_mfma_f32_16x16x32_bf16 v[208:211], v[80:83], a[100:103], v[208:211]
    v_exp_f32 v70, v70
    v_mfma_f32_16x16x32_bf16 v[212:215], v[84:87], a[100:103], v[212:215]
    v_add_f32 v5, v5, v70
    v_cvt_pk_bf16_f32 v102, v68, v69
    v_mfma_f32_16x16x32_bf16 v[216:219], v[88:91], a[100:103], v[216:219]
    v_exp_f32 v71, v71
    v_mfma_f32_16x16x32_bf16 v[220:223], v[92:95], a[100:103], v[220:223]
    ds_read_b128 a[108:111], v1 offset:15360
    v_add_f32 v5, v5, v71
    v_mfma_f32_16x16x32_bf16 v[40:43], a[80:83], a[32:35], v[120:123]
    v_exp_f32 v72, v72
    v_mfma_f32_16x16x32_bf16 v[40:43], a[84:87], a[36:39], v[40:43]
    v_add_f32 v6, v6, v72
    v_cvt_pk_bf16_f32 v103, v70, v71
    v_mfma_f32_16x16x32_bf16 v[40:43], a[88:91], a[40:43], v[40:43]
    s_waitcnt lgkmcnt(2)
    v_exp_f32 v73, v73
    v_mfma_f32_16x16x32_bf16 v[40:43], a[92:95], a[44:47], v[40:43]
    ds_read_b128 a[76:79], v1 offset:19456
    v_add_f32 v6, v6, v73
    v_mfma_f32_16x16x32_bf16 v[224:227], v[80:83], a[104:107], v[224:227]
    v_exp_f32 v74, v74
    v_mfma_f32_16x16x32_bf16 v[228:231], v[84:87], a[104:107], v[228:231]
    v_add_f32 v6, v6, v74
    v_cvt_pk_bf16_f32 v106, v72, v73
    v_mfma_f32_16x16x32_bf16 v[232:235], v[88:91], a[104:107], v[232:235]
    v_exp_f32 v75, v75
    v_mfma_f32_16x16x32_bf16 v[236:239], v[92:95], a[104:107], v[236:239]
    ds_read_b128 a[96:99], v1 offset:24576
    v_add_f32 v6, v6, v75
    v_mfma_f32_16x16x32_bf16 v[44:47], a[80:83], a[48:51], v[124:127]
    v_exp_f32 v76, v76
    v_mfma_f32_16x16x32_bf16 v[44:47], a[84:87], a[52:55], v[44:47]
    ds_read_b128 a[80:83], v1 offset:20480
    v_cvt_pk_bf16_f32 v107, v74, v75
    v_mfma_f32_16x16x32_bf16 v[44:47], a[88:91], a[56:59], v[44:47]
    s_waitcnt lgkmcnt(3)
    v_exp_f32 v77, v77
    v_mfma_f32_16x16x32_bf16 v[44:47], a[92:95], a[60:63], v[44:47]
    buffer_load_dwordx4 v3, s[8:11], s18 offen offset:2048 sc1 lds
    v_mfma_f32_16x16x32_bf16 v[240:243], v[80:83], a[108:111], v[240:243]
    v_exp_f32 v78, v78
    v_mfma_f32_16x16x32_bf16 v[244:247], v[84:87], a[108:111], v[244:247]
    ds_read_b128 a[100:103], v1 offset:25600
    v_cvt_pk_bf16_f32 v110, v76, v77
    v_mfma_f32_16x16x32_bf16 v[248:251], v[88:91], a[108:111], v[248:251]
    s_waitcnt lgkmcnt(3)
    v_exp_f32 v79, v79
    v_mfma_f32_16x16x32_bf16 v[252:255], v[92:95], a[108:111], v[252:255]
    buffer_load_dwordx4 v3, s[8:11], s18 offen offset:3072 sc1 lds
M_pos2:
    v_mfma_f32_16x16x32_bf16 v[48:51], a[64:67], a[0:3], v[112:115]
    s_add_u32 s18, s18, 0x4000
    v_exp_f32 v16, v16
    v_mfma_f32_16x16x32_bf16 v[48:51], a[68:71], a[4:7], v[48:51]
    s_and_b32 s18, s18, 0xfffff
    v_add_f32 v4, v4, v16
    v_cvt_pk_bf16_f32 v111, v78, v79
    v_mfma_f32_16x16x32_bf16 v[48:51], a[72:75], a[8:11], v[48:51]
    s_waitcnt lgkmcnt(2)
    v_exp_f32 v17, v17
    v_mfma_f32_16x16x32_bf16 v[48:51], a[76:79], a[12:15], v[48:51]
    ds_read_b128 a[84:87], v1 offset:21504
    v_add_f32 v4, v4, v17
    v_mfma_f32_16x16x32_bf16 v[128:131], v[96:99], a[96:99], v[128:131]
    s_xor_b32 m0, s17, 98304
    v_exp_f32 v18, v18
    v_mfma_f32_16x16x32_bf16 v[132:135], v[100:103], a[96:99], v[132:135]
    v_add_f32 v4, v4, v18
    v_cvt_pk_bf16_f32 v80, v16, v17
    v_mfma_f32_16x16x32_bf16 v[136:139], v[104:107], a[96:99], v[136:139]
    v_exp_f32 v19, v19
    v_mfma_f32_16x16x32_bf16 v[140:143], v[108:111], a[96:99], v[140:143]
    ds_read_b128 a[104:107], v1 offset:26624
    v_add_f32 v4, v4, v19
    v_mfma_f32_16x16x32_bf16 v[52:55], a[64:67], a[16:19], v[116:119]
    v_exp_f32 v20, v20
    v_mfma_f32_16x16x32_bf16 v[52:55], a[68:71], a[20:23], v[52:55]
    v_add_f32 v5, v5, v20
    v_cvt_pk_bf16_f32 v81, v18, v19
    v_mfma_f32_16x16x32_bf16 v[52:55], a[72:75], a[24:27], v[52:55]
    s_waitcnt lgkmcnt(2)
    v_exp_f32 v21, v21
    v_mfma_f32_16x16x32_bf16 v[52:55], a[76:79], a[28:31], v[52:55]
    ds_read_b128 a[88:91], v1 offset:22528
    v_add_f32 v5, v5, v21
    v_mfma_f32_16x16x32_bf16 v[144:147], v[96:99], a[100:103], v[144:147]
    v_exp_f32 v22, v22
    v_mfma_f32_16x16x32_bf16 v[148:151], v[100:103], a[100:103], v[148:151]
    v_add_f32 v5, v5, v22
    v_cvt_pk_bf16_f32 v84, v20, v21
    v_mfma_f32_16x16x32_bf16 v[152:155], v[104:107], a[100:103], v[152:155]
    v_exp_f32 v23, v23
    v_mfma_f32_16x16x32_bf16 v[156:159], v[108:111], a[100:103], v[156:159]
    ds_read_b128 a[108:111], v1 offset:27648
    v_add_f32 v5, v5, v23
    v_mfma_f32_16x16x32_bf16 v[56:59], a[64:67], a[32:35], v[120:123]
    v_exp_f32 v24, v24
    v_mfma_f32_16x16x32_bf16 v[56:59], a[68:71], a[36:39], v[56:59]
    v_add_f32 v6, v6, v24
    v_cvt_pk_bf16_f32 v85, v22, v23
    v_mfma_f32_16x16x32_bf16 v[56:59], a[72:75], a[40:43], v[56:59]
    s_waitcnt lgkmcnt(2)
    v_exp_f32 v25, v25
    v_mfma_f32_16x16x32_bf16 v[56:59], a[76:79], a[44:47], v[56:59]
    ds_read_b128 a[92:95], v1 offset:23552
    v_add_f32 v6, v6, v25
    v_mfma_f32_16x16x32_bf16 v[160:163], v[96:99], a[104:107], v[160:163]
    v_exp_f32 v26, v26
    v_mfma_f32_16x16x32_bf16 v[164:167], v[100:103], a[104:107], v[164:167]
    v_add_f32 v6, v6, v26
    v_cvt_pk_bf16_f32 v88, v24, v25
    v_mfma_f32_16x16x32_bf16 v[168:171], v[104:107], a[104:107], v[168:171]
    v_exp_f32 v27, v27
    v_mfma_f32_16x16x32_bf16 v[172:175], v[108:111], a[104:107], v[172:175]
    ds_read_b128 a[96:99], v1 offset:28672
    v_add_f32 v6, v6, v27
    v_mfma_f32_16x16x32_bf16 a[128:131], a[112:115], v[108:111], a[128:131]
    v_mfma_f32_16x16x32_bf16 v[60:63], a[64:67], a[48:51], v[124:127]
    v_exp_f32 v28, v28
    v_mfma_f32_16x16x32_bf16 v[60:63], a[68:71], a[52:55], v[60:63]
    ds_read_b128 a[64:67], v1 offset:32768
    v_cvt_pk_bf16_f32 v89, v26, v27
    v_mfma_f32_16x16x32_bf16 v[60:63], a[72:75], a[56:59], v[60:63]
    s_waitcnt lgkmcnt(3)
    v_exp_f32 v29, v29
    v_mfma_f32_16x16x32_bf16 v[60:63], a[76:79], a[60:63], v[60:63]
    buffer_load_dwordx4 v3, s[8:11], s18 offen offset:0 sc1 lds
    v_mfma_f32_16x16x32_bf16 v[176:179], v[96:99], a[108:111], v[176:179]
    v_exp_f32 v30, v30
    v_mfma_f32_16x16x32_bf16 v[180:183], v[100:103], a[108:111], v[180:183]
    ds_read_b128 a[100:103], v1 offset:29696
    v_cvt_pk_bf16_f32 v92, v28, v29
    v_mfma_f32_16x16x32_bf16 v[184:187], v[104:107], a[108:111], v[184:187]
    s_waitcnt lgkmcnt(3)
    v_exp_f32 v31, v31
    v_mfma_f32_16x16x32_bf16 v[188:191], v[108:111], a[108:111], v[188:191]
    buffer_load_dwordx4 v3, s[8:11], s18 offen offset:1024 sc1 lds
    v_mfma_f32_16x16x32_bf16 v[64:67], a[80:83], a[0:3], v[112:115]
    v_exp_f32 v32, v32
    v_mfma_f32_16x16x32_bf16 v[64:67], a[84:87], a[4:7], v[64:67]
    v_add_f32 v4, v4, v32
    v_cvt_pk_bf16_f32 v93, v30, v31
    v_mfma_f32_16x16x32_bf16 v[64:67], a[88:91], a[8:11], v[64:67]
    s_waitcnt lgkmcnt(2)
    v_exp_f32 v33, v33
    v_mfma_f32_16x16x32_bf16 v[64:67], a[92:95], a[12:15], v[64:67]
    ds_read_b128 a[68:71], v1 offset:33792
    v_add_f32 v4, v4, v33
    v_mfma_f32_16x16x32_bf16 v[192:195], v[96:99], a[96:99], v[192:195]
    v_exp_f32 v34, v34
    v_mfma_f32_16x16x32_bf16 v[196:199], v[100:103], a[96:99], v[196:199]
    v_add_f32 v4, v4, v34
    v_cvt_pk_bf16_f32 v82, v32, v33
    v_mfma_f32_16x16x32_bf16 v[200:203], v[104:107], a[96:99], v[200:203]
    v_exp_f32 v35, v35
    v_mfma_f32_16x16x32_bf16 v[204:207], v[108:111], a[96:99], v[204:207]
    ds_read_b128 a[104:107], v1 offset:30720
    v_add_f32 v4, v4, v35
    v_mfma_f32_16x16x32_bf16 v[68:71], a[80:83], a[16:19], v[116:119]
    v_exp_f32 v36, v36
    v_mfma_f32_16x16x32_bf16 v[68:71], a[84:87], a[20:23], v[68:71]
    v_add_f32 v5, v5, v36
    v_cvt_pk_bf16_f32 v83, v34, v35
    v_mfma_f32_16x16x32_bf16 v[68:71], a[88:91], a[24:27], v[68:71]
    s_waitcnt lgkmcnt(2)
    v_exp_f32 v37, v37
    v_mfma_f32_16x16x32_bf16 v[68:71], a[92:95], a[28:31], v[68:71]
    ds_read_b128 a[72:75], v1 offset:34816
    v_add_f32 v5, v5, v37
    v_mfma_f32_16x16x32_bf16 v[208:211], v[96:99], a[100:103], v[208:211]
    v_exp_f32 v38, v38
    v_mfma_f32_16x16x32_bf16 v[212:215], v[100:103], a[100:103], v[212:215]
    v_add_f32 v5, v5, v38
    v_cvt_pk_bf16_f32 v86, v36, v37
    v_mfma_f32_16x16x32_bf16 v[216:219], v[104:107], a[100:103], v[216:219]
    v_exp_f32 v39, v39
    v_mfma_f32_16x16x32_bf16 v[220:223], v[108:111], a[100:103], v[220:223]
    ds_read_b128 a[108:111], v1 offset:31744
    v_add_f32 v5, v5, v39
    v_mfma_f32_16x16x32_bf16 v[72:75], a[80:83], a[32:35], v[120:123]
    v_exp_f32 v40, v40
    v_mfma_f32_16x16x32_bf16 v[72:75], a[84:87], a[36:39], v[72:75]
    v_add_f32 v6, v6, v40
    v_cvt_pk_bf16_f32 v87, v38, v39
    v_mfma_f32_16x16x32_bf16 v[72:75], a[88:91], a[40:43], v[72:75]
    s_waitcnt lgkmcnt(2)
    v_exp_f32 v41, v41
    v_mfma_f32_16x16x32_bf16 v[72:75], a[92:95], a[44:47], v[72:75]
    ds_read_b128 a[76:79], v1 offset:35840
    v_add_f32 v6, v6, v41
    v_mfma_f32_16x16x32_bf16 v[224:227], v[96:99], a[104:107], v[224:227]
    v_exp_f32 v42, v42
    v_mfma_f32_16x16x32_bf16 v[228:231], v[100:103], a[104:107], v[228:231]
    v_add_f32 v6, v6, v42
    v_cvt_pk_bf16_f32 v90, v40, v41
    v_mfma_f32_16x16x32_bf16 v[232:235], v[104:107], a[104:107], v[232:235]
    v_exp_f32 v43, v43
    v_mfma_f32_16x16x32_bf16 v[236:239], v[108:111], a[104:107], v[236:239]
    ds_read_b128 a[96:99], v1 offset:40960
    v_add_f32 v6, v6, v43
    v_mfma_f32_16x16x32_bf16 v[76:79], a[80:83], a[48:51], v[124:127]
    s_xor_b32 s17, s17, 0x10000
    v_exp_f32 v44, v44
    v_mfma_f32_16x16x32_bf16 v[76:79], a[84:87], a[52:55], v[76:79]
    ds_read_b128 a[80:83], v1 offset:36864
    v_cvt_pk_bf16_f32 v91, v42, v43
    v_mfma_f32_16x16x32_bf16 v[76:79], a[88:91], a[56:59], v[76:79]
    s_waitcnt lgkmcnt(3)
    v_exp_f32 v45, v45
    v_mfma_f32_16x16x32_bf16 v[76:79], a[92:95], a[60:63], v[76:79]
    buffer_load_dwordx4 v3, s[8:11], s18 offen offset:2048 sc1 lds
    v_mfma_f32_16x16x32_bf16 v[240:243], v[96:99], a[108:111], v[240:243]
    s_sub_u32 s19, s19, 1
    v_exp_f32 v46, v46
    v_mfma_f32_16x16x32_bf16 v[244:247], v[100:103], a[108:111], v[244:247]
    ds_read_b128 a[100:103], v1 offset:41984
    v_cvt_pk_bf16_f32 v94, v44, v45
    v_mfma_f32_16x16x32_bf16 v[248:251], v[104:107], a[108:111], v[248:251]
    s_waitcnt lgkmcnt(3)
    s_cmp_lg_u32 s19, 0
    v_exp_f32 v47, v47
    v_mfma_f32_16x16x32_bf16 v[252:255], v[108:111], a[108:111], v[252:255]
    buffer_load_dwordx4 v3, s[8:11], s18 offen offset:3072 sc1 lds
    v_swap_b32 v1, v2
    s_cbranch_scc1 M_pos3
    v_exp_f32 v48, v48
    s_nop 0
    v_add_f32 v4, v4, v48
    v_cvt_pk_bf16_f32 v95, v46, v47
    s_waitcnt lgkmcnt(2)
    v_exp_f32 v49, v49
    s_nop 0
    v_add_f32 v4, v4, v49
    v_mfma_f32_16x16x32_bf16 v[128:131], v[80:83], a[96:99], v[128:131]
    v_exp_f32 v50, v50
    v_mfma_f32_16x16x32_bf16 v[132:135], v[84:87], a[96:99], v[132:135]
    v_add_f32 v4, v4, v50
    v_cvt_pk_bf16_f32 v96, v48, v49
    v_mfma_f32_16x16x32_bf16 v[136:139], v[88:91], a[96:99], v[136:139]
    v_exp_f32 v51, v51
    v_mfma_f32_16x16x32_bf16 v[140:143], v[92:95], a[96:99], v[140:143]
    ds_read_b128 a[104:107], v2 offset:43008
    v_add_f32 v4, v4, v51
    v_exp_f32 v52, v52
    s_nop 0
    v_add_f32 v5, v5, v52
    v_cvt_pk_bf16_f32 v97, v50, v51
    s_waitcnt lgkmcnt(1)
    v_exp_f32 v53, v53
    s_nop 0
    v_add_f32 v5, v5, v53
    v_mfma_f32_16x16x32_bf16 v[144:147], v[80:83], a[100:103], v[144:147]
    v_exp_f32 v54, v54
    v_mfma_f32_16x16x32_bf16 v[148:151], v[84:87], a[100:103], v[148:151]
    v_add_f32 v5, v5, v54
    v_cvt_pk_bf16_f32 v100, v52, v53
    v_mfma_f32_16x16x32_bf16 v[152:155], v[88:91], a[100:103], v[152:155]
    v_exp_f32 v55, v55
    v_mfma_f32_16x16x32_bf16 v[156:159], v[92:95], a[100:103], v[156:159]
    ds_read_b128 a[108:111], v2 offset:44032
    v_add_f32 v5, v5, v55
    v_exp_f32 v56, v56
    s_nop 0
    v_add_f32 v6, v6, v56
    v_cvt_pk_bf16_f32 v101, v54, v55
    s_waitcnt lgkmcnt(1)
    v_exp_f32 v57, v57
    s_nop 0
    v_add_f32 v6, v6, v57
    v_mfma_f32_16x16x32_bf16 v[160:163], v[80:83], a[104:107], v[160:163]
    v_exp_f32 v58, v58
    v_mfma_f32_16x16x32_bf16 v[164:167], v[84:87], a[104:107], v[164:167]
    s_waitcnt vmcnt(8)
    v_add_f32 v6, v6, v58
    v_cvt_pk_bf16_f32 v104, v56, v57
    v_mfma_f32_16x16x32_bf16 v[168:171], v[88:91], a[104:107], v[168:171]
    v_exp_f32 v59, v59
    v_mfma_f32_16x16x32_bf16 v[172:175], v[92:95], a[104:107], v[172:175]
    ds_read_b128 a[96:99], v2 offset:45056
    v_add_f32 v6, v6, v59
    v_mfma_f32_16x16x32_bf16 a[128:131], a[112:115], v[92:95], a[128:131]
    s_barrier
    v_exp_f32 v60, v60
    v_cvt_pk_bf16_f32 v105, v58, v59
    s_waitcnt lgkmcnt(1)
    v_exp_f32 v61, v61
    v_mfma_f32_16x16x32_bf16 v[176:179], v[80:83], a[108:111], v[176:179]
    v_exp_f32 v62, v62
    v_mfma_f32_16x16x32_bf16 v[180:183], v[84:87], a[108:111], v[180:183]
    ds_read_b128 a[100:103], v2 offset:46080
    v_cvt_pk_bf16_f32 v108, v60, v61
    v_mfma_f32_16x16x32_bf16 v[184:187], v[88:91], a[108:111], v[184:187]
    v_exp_f32 v63, v63
    v_mfma_f32_16x16x32_bf16 v[188:191], v[92:95], a[108:111], v[188:191]
    v_exp_f32 v64, v64
    s_nop 0
    v_add_f32 v4, v4, v64
    v_cvt_pk_bf16_f32 v109, v62, v63
    s_waitcnt lgkmcnt(1)
    v_exp_f32 v65, v65
    s_nop 0
    v_add_f32 v4, v4, v65
    v_mfma_f32_16x16x32_bf16 v[192:195], v[80:83], a[96:99], v[192:195]
    v_exp_f32 v66, v66
    v_mfma_f32_16x16x32_bf16 v[196:199], v[84:87], a[96:99], v[196:199]
    v_add_f32 v4, v4, v66
    v_cvt_pk_bf16_f32 v98, v64, v65
    v_mfma_f32_16x16x32_bf16 v[200:203], v[88:91], a[96:99], v[200:203]
    v_exp_f32 v67, v67
    v_mfma_f32_16x16x32_bf16 v[204:207], v[92:95], a[96:99], v[204:207]
    ds_read_b128 a[104:107], v2 offset:47104
    v_add_f32 v4, v4, v67
    v_exp_f32 v68, v68
    s_nop 0
    v_add_f32 v5, v5, v68
    v_cvt_pk_bf16_f32 v99, v66, v67
    s_waitcnt lgkmcnt(1)
    v_exp_f32 v69, v69
    s_nop 0
    v_add_f32 v5, v5, v69
    v_mfma_f32_16x16x32_bf16 v[208:211], v[80:83], a[100:103], v[208:211]
    v_exp_f32 v70, v70
    v_mfma_f32_16x16x32_bf16 v[212:215], v[84:87], a[100:103], v[212:215]
    v_add_f32 v5, v5, v70
    v_cvt_pk_bf16_f32 v102, v68, v69
    v_mfma_f32_16x16x32_bf16 v[216:219], v[88:91], a[100:103], v[216:219]
    v_exp_f32 v71, v71
    v_mfma_f32_16x16x32_bf16 v[220:223], v[92:95], a[100:103], v[220:223]
    ds_read_b128 a[108:111], v2 offset:48128
    v_add_f32 v5, v5, v71
    v_exp_f32 v72, v72
    s_nop 0
    v_add_f32 v6, v6, v72
    v_cvt_pk_bf16_f32 v103, v70, v71
    s_waitcnt lgkmcnt(1)
    v_exp_f32 v73, v73
    s_nop 0
    v_add_f32 v6, v6, v73
    v_mfma_f32_16x16x32_bf16 v[224:227], v[80:83], a[104:107], v[224:227]
    v_exp_f32 v74, v74
    v_mfma_f32_16x16x32_bf16 v[228:231], v[84:87], a[104:107], v[228:231]
    v_add_f32 v6, v6, v74
    v_cvt_pk_bf16_f32 v106, v72, v73
    v_mfma_f32_16x16x32_bf16 v[232:235], v[88:91], a[104:107], v[232:235]
    v_exp_f32 v75, v75
    v_mfma_f32_16x16x32_bf16 v[236:239], v[92:95], a[104:107], v[236:239]
    ds_read_b128 a[96:99], v2 offset:57344
    v_add_f32 v6, v6, v75
    v_exp_f32 v76, v76
    v_cvt_pk_bf16_f32 v107, v74, v75
    s_waitcnt lgkmcnt(1)
    v_exp_f32 v77, v77
    v_mfma_f32_16x16x32_bf16 v[240:243], v[80:83], a[108:111], v[240:243]
    v_exp_f32 v78, v78
    v_mfma_f32_16x16x32_bf16 v[244:247], v[84:87], a[108:111], v[244:247]
    ds_read_b128 a[100:103], v2 offset:58368
    v_cvt_pk_bf16_f32 v110, v76, v77
    v_mfma_f32_16x16x32_bf16 v[248:251], v[88:91], a[108:111], v[248:251]
    v_exp_f32 v79, v79
    v_mfma_f32_16x16x32_bf16 v[252:255], v[92:95], a[108:111], v[252:255]
    v_cvt_pk_bf16_f32 v111, v78, v79
    ds_read_b128 a[64:67], v2 offset:59392
    ds_read_b128 a[68:71], v2 offset:60416
    ds_read_b128 a[72:75], v2 offset:61440
    ds_read_b128 a[76:79], v2 offset:62464
    ds_read_b128 a[80:83], v2 offset:63488
    ds_read_b128 a[84:87], v2 offset:64512
    s_waitcnt vmcnt(0)
    v_mfma_f32_16x16x32_bf16 a[128:131], a[112:115], v[108:111], a[128:131]
    s_waitcnt lgkmcnt(6)
    v_mfma_f32_16x16x32_bf16 v[128:131], v[96:99], a[96:99], v[128:131]
    v_lshrrev_b32 v116, 4, v0
    v_lshlrev_b32 v112, 10, v116
    v_and_b32 v113, 3, v0
    v_lshl_add_u32 v112, v113, 6, v112
    v_bfe_u32 v113, v0, 2, 2
    v_lshl_add_u32 v112, v113, 4, v112
    v_add_u32 v113, 4096, v112
    v_add_u32 v114, 8192, v112
    s_waitcnt lgkmcnt(6)
    v_mfma_f32_16x16x32_bf16 v[144:147], v[96:99], a[100:103], v[144:147]
    v_add_u32 v115, 12288, v112
    v_lshlrev_b32 v116, 4, v116
    s_mov_b32 s52, 0x55555555
    s_mov_b32 s53, 0x55555555
    s_mov_b32 s54, 0xaaaaaaaa
    s_mov_b32 s55, 0xaaaaaaaa
    s_mov_b32 s56, 0x33333333
    s_mov_b32 s57, 0x33333333
    s_waitcnt lgkmcnt(5)
    v_mfma_f32_16x16x32_bf16 v[160:163], v[96:99], a[64:67], v[160:163]
    s_mov_b32 s58, 0xcccccccc
    s_mov_b32 s59, 0xcccccccc
    v_mov_b32 v12, v4
    v_mov_b32 v13, v5
    v_mov_b32 v14, v6
    s_nop 1
    v_permlane32_swap_b32 v4, v12
    v_permlane32_swap_b32 v5, v13
    s_waitcnt lgkmcnt(4)
    v_mfma_f32_16x16x32_bf16 v[176:179], v[96:99], a[68:71], v[176:179]
    v_permlane32_swap_b32 v6, v14
    s_nop 1
    v_add_f32 v4, v4, v12
    v_add_f32 v5, v5, v13
    v_add_f32 v6, v6, v14
    v_mov_b32 v12, v4
    v_mov_b32 v13, v5
    v_mov_b32 v14, v6
    s_waitcnt lgkmcnt(3)
    v_mfma_f32_16x16x32_bf16 v[192:195], v[96:99], a[72:75], v[192:195]
    s_nop 1
    v_permlane16_swap_b32 v4, v12
    v_permlane16_swap_b32 v5, v13
    v_permlane16_swap_b32 v6, v14
    s_nop 1
    v_add_f32 v4, v4, v12
    v_add_f32 v5, v5, v13
    v_add_f32 v6, v6, v14
    s_waitcnt lgkmcnt(2)
    v_mfma_f32_16x16x32_bf16 v[208:211], v[96:99], a[76:79], v[208:211]
    v_accvgpr_read_b32 v7, a128
    v_add_f32 v12, v4, v5
    v_add_f32 v12, v12, v6
    v_add_f32 v12, v12, v7
    v_mov_b32 v13, 0x4c800000
    v_cmp_nle_f32 vcc, v12, v13
    v_rcp_f32 v8, v4
    v_rcp_f32 v9, v5
    s_waitcnt lgkmcnt(1)
    v_mfma_f32_16x16x32_bf16 v[224:227], v[96:99], a[80:83], v[224:227]
    v_rcp_f32 v10, v6
    v_rcp_f32 v11, v7
    s_nop 0
    v_fma_f32 v12, -v4, v8, 2.0
    v_fma_f32 v13, -v5, v9, 2.0
    v_fma_f32 v14, -v6, v10, 2.0
    v_fma_f32 v15, -v7, v11, 2.0
    v_mul_f32 v8, v8, v12
    s_waitcnt lgkmcnt(0)
    v_mfma_f32_16x16x32_bf16 v[240:243], v[96:99], a[84:87], v[240:243]
    v_mul_f32 v9, v9, v13
    v_mul_f32 v10, v10, v14
    v_mul_f32 v11, v11, v15
    s_cbranch_vccnz M_safe
    ds_bpermute_b32 v80, v116, v8 offset:0
    ds_bpermute_b32 v81, v116, v8 offset:4
    ds_bpermute_b32 v82, v116, v8 offset:8
    ds_bpermute_b32 v83, v116, v8 offset:12
    v_mfma_f32_16x16x32_bf16 v[132:135], v[100:103], a[96:99], v[132:135]
    s_waitcnt lgkmcnt(0)
    ds_bpermute_b32 v84, v116, v9 offset:0
    ds_bpermute_b32 v85, v116, v9 offset:4
    ds_bpermute_b32 v86, v116, v9 offset:8
    ds_bpermute_b32 v87, v116, v9 offset:12
    v_mul_f32 v128, v128, v80
    v_mul_f32 v144, v144, v80
    v_cvt_pk_bf16_f32 v16, v128, v144
    v_mul_f32 v160, v160, v80
    v_mul_f32 v176, v176, v80
    v_cvt_pk_bf16_f32 v17, v160, v176
    v_mul_f32 v192, v192, v80
    v_mul_f32 v208, v208, v80
    v_cvt_pk_bf16_f32 v18, v192, v208
    v_mfma_f32_16x16x32_bf16 v[148:151], v[100:103], a[100:103], v[148:151]
    v_mul_f32 v224, v224, v80
    v_mul_f32 v240, v240, v80
    v_cvt_pk_bf16_f32 v19, v224, v240
    s_mov_b64 vcc, s[52:53]
    v_cndmask_b32_dpp v32, v17, v16, vcc quad_perm:[1,0,3,2] row_mask:0xf bank_mask:0xf
    v_cndmask_b32_dpp v34, v19, v18, vcc quad_perm:[1,0,3,2] row_mask:0xf bank_mask:0xf
    s_mov_b64 vcc, s[54:55]
    v_cndmask_b32_dpp v33, v16, v17, vcc quad_perm:[1,0,3,2] row_mask:0xf bank_mask:0xf
    v_cndmask_b32_dpp v35, v18, v19, vcc quad_perm:[1,0,3,2] row_mask:0xf bank_mask:0xf
    s_mov_b64 vcc, s[56:57]
    v_cndmask_b32_dpp v16, v34, v32, vcc quad_perm:[2,3,0,1] row_mask:0xf bank_mask:0xf
    v_cndmask_b32_dpp v17, v35, v33, vcc quad_perm:[2,3,0,1] row_mask:0xf bank_mask:0xf
    s_mov_b64 vcc, s[58:59]
    v_cndmask_b32_dpp v18, v32, v34, vcc quad_perm:[2,3,0,1] row_mask:0xf bank_mask:0xf
    v_mfma_f32_16x16x32_bf16 v[164:167], v[100:103], a[64:67], v[164:167]
    v_cndmask_b32_dpp v19, v33, v35, vcc quad_perm:[2,3,0,1] row_mask:0xf bank_mask:0xf
    buffer_store_dwordx4 v[16:19], v112, s[12:15], 0 offen offset:0 sc1 nt
    v_mul_f32 v129, v129, v81
    v_mul_f32 v145, v145, v81
    v_cvt_pk_bf16_f32 v20, v129, v145
    v_mul_f32 v161, v161, v81
    v_mul_f32 v177, v177, v81
    v_cvt_pk_bf16_f32 v21, v161, v177
    v_mul_f32 v193, v193, v81
    v_mul_f32 v209, v209, v81
    v_cvt_pk_bf16_f32 v22, v193, v209
    v_mul_f32 v225, v225, v81
    v_mul_f32 v241, v241, v81
    v_cvt_pk_bf16_f32 v23, v225, v241
    v_mfma_f32_16x16x32_bf16 v[180:183], v[100:103], a[68:71], v[180:183]
    s_mov_b64 vcc, s[52:53]
    v_cndmask_b32_dpp v36, v21, v20, vcc quad_perm:[1,0,3,2] row_mask:0xf bank_mask:0xf
    v_cndmask_b32_dpp v38, v23, v22, vcc quad_perm:[1,0,3,2] row_mask:0xf bank_mask:0xf
    s_mov_b64 vcc, s[54:55]
    v_cndmask_b32_dpp v37, v20, v21, vcc quad_perm:[1,0,3,2] row_mask:0xf bank_mask:0xf
    v_cndmask_b32_dpp v39, v22, v23, vcc quad_perm:[1,0,3,2] row_mask:0xf bank_mask:0xf
    s_mov_b64 vcc, s[56:57]
    v_cndmask_b32_dpp v20, v38, v36, vcc quad_perm:[2,3,0,1] row_mask:0xf bank_mask:0xf
    v_cndmask_b32_dpp v21, v39, v37, vcc quad_perm:[2,3,0,1] row_mask:0xf bank_mask:0xf
    s_mov_b64 vcc, s[58:59]
    v_cndmask_b32_dpp v22, v36, v38, vcc quad_perm:[2,3,0,1] row_mask:0xf bank_mask:0xf
    v_cndmask_b32_dpp v23, v37, v39, vcc quad_perm:[2,3,0,1] row_mask:0xf bank_mask:0xf
    buffer_store_dwordx4 v[20:23], v112, s[12:15], 0 offen offset:256 sc1 nt
    v_mul_f32 v130, v130, v82
    v_mfma_f32_16x16x32_bf16 v[196:199], v[100:103], a[72:75], v[196:199]
    v_mul_f32 v146, v146, v82
    v_cvt_pk_bf16_f32 v24, v130, v146
    v_mul_f32 v162, v162, v82
    v_mul_f32 v178, v178, v82
    v_cvt_pk_bf16_f32 v25, v162, v178
    v_mul_f32 v194, v194, v82
    v_mul_f32 v210, v210, v82
    v_cvt_pk_bf16_f32 v26, v194, v210
    v_mul_f32 v226, v226, v82
    v_mul_f32 v242, v242, v82
    v_cvt_pk_bf16_f32 v27, v226, v242
    s_mov_b64 vcc, s[52:53]
    v_cndmask_b32_dpp v40, v25, v24, vcc quad_perm:[1,0,3,2] row_mask:0xf bank_mask:0xf
    v_cndmask_b32_dpp v42, v27, v26, vcc quad_perm:[1,0,3,2] row_mask:0xf bank_mask:0xf
    v_mfma_f32_16x16x32_bf16 v[212:215], v[100:103], a[76:79], v[212:215]
    s_mov_b64 vcc, s[54:55]
    v_cndmask_b32_dpp v41, v24, v25, vcc quad_perm:[1,0,3,2] row_mask:0xf bank_mask:0xf
    v_cndmask_b32_dpp v43, v26, v27, vcc quad_perm:[1,0,3,2] row_mask:0xf bank_mask:0xf
    s_mov_b64 vcc, s[56:57]
    v_cndmask_b32_dpp v24, v42, v40, vcc quad_perm:[2,3,0,1] row_mask:0xf bank_mask:0xf
    v_cndmask_b32_dpp v25, v43, v41, vcc quad_perm:[2,3,0,1] row_mask:0xf bank_mask:0xf
    s_mov_b64 vcc, s[58:59]
    v_cndmask_b32_dpp v26, v40, v42, vcc quad_perm:[2,3,0,1] row_mask:0xf bank_mask:0xf
    v_cndmask_b32_dpp v27, v41, v43, vcc quad_perm:[2,3,0,1] row_mask:0xf bank_mask:0xf
    buffer_store_dwordx4 v[24:27], v112, s[12:15], 0 offen offset:512 sc1 nt
    v_mul_f32 v131, v131, v83
    v_mul_f32 v147, v147, v83
    v_cvt_pk_bf16_f32 v28, v131, v147
    v_mul_f32 v163, v163, v83
    v_mfma_f32_16x16x32_bf16 v[228:231], v[100:103], a[80:83], v[228:231]
    v_mul_f32 v179, v179, v83
    v_cvt_pk_bf16_f32 v29, v163, v179
    v_mul_f32 v195, v195, v83
    v_mul_f32 v211, v211, v83
    v_cvt_pk_bf16_f32 v30, v195, v211
    v_mul_f32 v227, v227, v83
    v_mul_f32 v243, v243, v83
    v_cvt_pk_bf16_f32 v31, v227, v243
    s_mov_b64 vcc, s[52:53]
    v_cndmask_b32_dpp v44, v29, v28, vcc quad_perm:[1,0,3,2] row_mask:0xf bank_mask:0xf
    v_cndmask_b32_dpp v46, v31, v30, vcc quad_perm:[1,0,3,2] row_mask:0xf bank_mask:0xf
    s_mov_b64 vcc, s[54:55]
    v_cndmask_b32_dpp v45, v28, v29, vcc quad_perm:[1,0,3,2] row_mask:0xf bank_mask:0xf
    v_cndmask_b32_dpp v47, v30, v31, vcc quad_perm:[1,0,3,2] row_mask:0xf bank_mask:0xf
    v_mfma_f32_16x16x32_bf16 v[244:247], v[100:103], a[84:87], v[244:247]
    s_mov_b64 vcc, s[56:57]
    v_cndmask_b32_dpp v28, v46, v44, vcc quad_perm:[2,3,0,1] row_mask:0xf bank_mask:0xf
    v_cndmask_b32_dpp v29, v47, v45, vcc quad_perm:[2,3,0,1] row_mask:0xf bank_mask:0xf
    s_mov_b64 vcc, s[58:59]
    v_cndmask_b32_dpp v30, v44, v46, vcc quad_perm:[2,3,0,1] row_mask:0xf bank_mask:0xf
    v_cndmask_b32_dpp v31, v45, v47, vcc quad_perm:[2,3,0,1] row_mask:0xf bank_mask:0xf
    buffer_store_dwordx4 v[28:31], v112, s[12:15], 0 offen offset:768 sc1 nt
    v_mfma_f32_16x16x32_bf16 v[136:139], v[104:107], a[96:99], v[136:139]
    s_waitcnt lgkmcnt(0)
    ds_bpermute_b32 v88, v116, v10 offset:0
    ds_bpermute_b32 v89, v116, v10 offset:4
    ds_bpermute_b32 v90, v116, v10 offset:8
    ds_bpermute_b32 v91, v116, v10 offset:12
    v_mul_f32 v132, v132, v84
    v_mul_f32 v148, v148, v84
    v_cvt_pk_bf16_f32 v48, v132, v148
    v_mul_f32 v164, v164, v84
    v_mul_f32 v180, v180, v84
    v_cvt_pk_bf16_f32 v49, v164, v180
    v_mul_f32 v196, v196, v84
    v_mul_f32 v212, v212, v84
    v_cvt_pk_bf16_f32 v50, v196, v212
    v_mfma_f32_16x16x32_bf16 v[152:155], v[104:107], a[100:103], v[152:155]
    v_mul_f32 v228, v228, v84
    v_mul_f32 v244, v244, v84
    v_cvt_pk_bf16_f32 v51, v228, v244
    s_mov_b64 vcc, s[52:53]
    v_cndmask_b32_dpp v32, v49, v48, vcc quad_perm:[1,0,3,2] row_mask:0xf bank_mask:0xf
    v_cndmask_b32_dpp v34, v51, v50, vcc quad_perm:[1,0,3,2] row_mask:0xf bank_mask:0xf
    s_mov_b64 vcc, s[54:55]
    v_cndmask_b32_dpp v33, v48, v49, vcc quad_perm:[1,0,3,2] row_mask:0xf bank_mask:0xf
    v_cndmask_b32_dpp v35, v50, v51, vcc quad_perm:[1,0,3,2] row_mask:0xf bank_mask:0xf
    s_mov_b64 vcc, s[56:57]
    v_cndmask_b32_dpp v48, v34, v32, vcc quad_perm:[2,3,0,1] row_mask:0xf bank_mask:0xf
    v_cndmask_b32_dpp v49, v35, v33, vcc quad_perm:[2,3,0,1] row_mask:0xf bank_mask:0xf
    s_mov_b64 vcc, s[58:59]
    v_cndmask_b32_dpp v50, v32, v34, vcc quad_perm:[2,3,0,1] row_mask:0xf bank_mask:0xf
    v_mfma_f32_16x16x32_bf16 v[168:171], v[104:107], a[64:67], v[168:171]
    v_cndmask_b32_dpp v51, v33, v35, vcc quad_perm:[2,3,0,1] row_mask:0xf bank_mask:0xf
    buffer_store_dwordx4 v[48:51], v113, s[12:15], 0 offen offset:0 sc1 nt
    v_mul_f32 v133, v133, v85
    v_mul_f32 v149, v149, v85
    v_cvt_pk_bf16_f32 v52, v133, v149
    v_mul_f32 v165, v165, v85
    v_mul_f32 v181, v181, v85
    v_cvt_pk_bf16_f32 v53, v165, v181
    v_mul_f32 v197, v197, v85
    v_mul_f32 v213, v213, v85
    v_cvt_pk_bf16_f32 v54, v197, v213
    v_mul_f32 v229, v229, v85
    v_mul_f32 v245, v245, v85
    v_cvt_pk_bf16_f32 v55, v229, v245
    v_mfma_f32_16x16x32_bf16 v[184:187], v[104:107], a[68:71], v[184:187]
    s_mov_b64 vcc, s[52:53]
    v_cndmask_b32_dpp v36, v53, v52, vcc quad_perm:[1,0,3,2] row_mask:0xf bank_mask:0xf
    v_cndmask_b32_dpp v38, v55, v54, vcc quad_perm:[1,0,3,2] row_mask:0xf bank_mask:0xf
    s_mov_b64 vcc, s[54:55]
    v_cndmask_b32_dpp v37, v52, v53, vcc quad_perm:[1,0,3,2] row_mask:0xf bank_mask:0xf
    v_cndmask_b32_dpp v39, v54, v55, vcc quad_perm:[1,0,3,2] row_mask:0xf bank_mask:0xf
    s_mov_b64 vcc, s[56:57]
    v_cndmask_b32_dpp v52, v38, v36, vcc quad_perm:[2,3,0,1] row_mask:0xf bank_mask:0xf
    v_cndmask_b32_dpp v53, v39, v37, vcc quad_perm:[2,3,0,1] row_mask:0xf bank_mask:0xf
    s_mov_b64 vcc, s[58:59]
    v_cndmask_b32_dpp v54, v36, v38, vcc quad_perm:[2,3,0,1] row_mask:0xf bank_mask:0xf
    v_cndmask_b32_dpp v55, v37, v39, vcc quad_perm:[2,3,0,1] row_mask:0xf bank_mask:0xf
    buffer_store_dwordx4 v[52:55], v113, s[12:15], 0 offen offset:256 sc1 nt
    v_mul_f32 v134, v134, v86
    v_mfma_f32_16x16x32_bf16 v[200:203], v[104:107], a[72:75], v[200:203]
    v_mul_f32 v150, v150, v86
    v_cvt_pk_bf16_f32 v56, v134, v150
    v_mul_f32 v166, v166, v86
    v_mul_f32 v182, v182, v86
    v_cvt_pk_bf16_f32 v57, v166, v182
    v_mul_f32 v198, v198, v86
    v_mul_f32 v214, v214, v86
    v_cvt_pk_bf16_f32 v58, v198, v214
    v_mul_f32 v230, v230, v86
    v_mul_f32 v246, v246, v86
    v_cvt_pk_bf16_f32 v59, v230, v246
    s_mov_b64 vcc, s[52:53]
    v_cndmask_b32_dpp v40, v57, v56, vcc quad_perm:[1,0,3,2] row_mask:0xf bank_mask:0xf
    v_cndmask_b32_dpp v42, v59, v58, vcc quad_perm:[1,0,3,2] row_mask:0xf bank_mask:0xf
    v_mfma_f32_16x16x32_bf16 v[216:219], v[104:107], a[76:79], v[216:219]
    s_mov_b64 vcc, s[54:55]
    v_cndmask_b32_dpp v41, v56, v57, vcc quad_perm:[1,0,3,2] row_mask:0xf bank_mask:0xf
    v_cndmask_b32_dpp v43, v58, v59, vcc quad_perm:[1,0,3,2] row_mask:0xf bank_mask:0xf
    s_mov_b64 vcc, s[56:57]
    v_cndmask_b32_dpp v56, v42, v40, vcc quad_perm:[2,3,0,1] row_mask:0xf bank_mask:0xf
    v_cndmask_b32_dpp v57, v43, v41, vcc quad_perm:[2,3,0,1] row_mask:0xf bank_mask:0xf
    s_mov_b64 vcc, s[58:59]
    v_cndmask_b32_dpp v58, v40, v42, vcc quad_perm:[2,3,0,1] row_mask:0xf bank_mask:0xf
    v_cndmask_b32_dpp v59, v41, v43, vcc quad_perm:[2,3,0,1] row_mask:0xf bank_mask:0xf
    buffer_store_dwordx4 v[56:59], v113, s[12:15], 0 offen offset:512 sc1 nt
    v_mul_f32 v135, v135, v87
    v_mul_f32 v151, v151, v87
    v_cvt_pk_bf16_f32 v60, v135, v151
    v_mul_f32 v167, v167, v87
    v_mfma_f32_16x16x32_bf16 v[232:235], v[104:107], a[80:83], v[232:235]
    v_mul_f32 v183, v183, v87
    v_cvt_pk_bf16_f32 v61, v167, v183
    v_mul_f32 v199, v199, v87
    v_mul_f32 v215, v215, v87
    v_cvt_pk_bf16_f32 v62, v199, v215
    v_mul_f32 v231, v231, v87
    v_mul_f32 v247, v247, v87
    v_cvt_pk_bf16_f32 v63, v231, v247
    s_mov_b64 vcc, s[52:53]
    v_cndmask_b32_dpp v44, v61, v60, vcc quad_perm:[1,0,3,2] row_mask:0xf bank_mask:0xf
    v_cndmask_b32_dpp v46, v63, v62, vcc quad_perm:[1,0,3,2] row_mask:0xf bank_mask:0xf
    s_mov_b64 vcc, s[54:55]
    v_cndmask_b32_dpp v45, v60, v61, vcc quad_perm:[1,0,3,2] row_mask:0xf bank_mask:0xf
    v_cndmask_b32_dpp v47, v62, v63, vcc quad_perm:[1,0,3,2] row_mask:0xf bank_mask:0xf
    v_mfma_f32_16x16x32_bf16 v[248:251], v[104:107], a[84:87], v[248:251]
    s_mov_b64 vcc, s[56:57]
    v_cndmask_b32_dpp v60, v46, v44, vcc quad_perm:[2,3,0,1] row_mask:0xf bank_mask:0xf
    v_cndmask_b32_dpp v61, v47, v45, vcc quad_perm:[2,3,0,1] row_mask:0xf bank_mask:0xf
    s_mov_b64 vcc, s[58:59]
    v_cndmask_b32_dpp v62, v44, v46, vcc quad_perm:[2,3,0,1] row_mask:0xf bank_mask:0xf
    v_cndmask_b32_dpp v63, v45, v47, vcc quad_perm:[2,3,0,1] row_mask:0xf bank_mask:0xf
    buffer_store_dwordx4 v[60:63], v113, s[12:15], 0 offen offset:768 sc1 nt
    v_mfma_f32_16x16x32_bf16 v[140:143], v[108:111], a[96:99], v[140:143]
    s_waitcnt lgkmcnt(0)
    ds_bpermute_b32 v92, v116, v11 offset:0
    ds_bpermute_b32 v93, v116, v11 offset:4
    ds_bpermute_b32 v94, v116, v11 offset:8
    ds_bpermute_b32 v95, v116, v11 offset:12
    v_mul_f32 v136, v136, v88
    v_mul_f32 v152, v152, v88
    v_cvt_pk_bf16_f32 v16, v136, v152
    v_mul_f32 v168, v168, v88
    v_mul_f32 v184, v184, v88
    v_cvt_pk_bf16_f32 v17, v168, v184
    v_mul_f32 v200, v200, v88
    v_mul_f32 v216, v216, v88
    v_cvt_pk_bf16_f32 v18, v200, v216
    v_mfma_f32_16x16x32_bf16 v[156:159], v[108:111], a[100:103], v[156:159]
    v_mul_f32 v232, v232, v88
    v_mul_f32 v248, v248, v88
    v_cvt_pk_bf16_f32 v19, v232, v248
    s_mov_b64 vcc, s[52:53]
    v_cndmask_b32_dpp v32, v17, v16, vcc quad_perm:[1,0,3,2] row_mask:0xf bank_mask:0xf
    v_cndmask_b32_dpp v34, v19, v18, vcc quad_perm:[1,0,3,2] row_mask:0xf bank_mask:0xf
    s_mov_b64 vcc, s[54:55]
    v_cndmask_b32_dpp v33, v16, v17, vcc quad_perm:[1,0,3,2] row_mask:0xf bank_mask:0xf
    v_cndmask_b32_dpp v35, v18, v19, vcc quad_perm:[1,0,3,2] row_mask:0xf bank_mask:0xf
    s_mov_b64 vcc, s[56:57]
    v_cndmask_b32_dpp v16, v34, v32, vcc quad_perm:[2,3,0,1] row_mask:0xf bank_mask:0xf
    v_cndmask_b32_dpp v17, v35, v33, vcc quad_perm:[2,3,0,1] row_mask:0xf bank_mask:0xf
    s_mov_b64 vcc, s[58:59]
    v_cndmask_b32_dpp v18, v32, v34, vcc quad_perm:[2,3,0,1] row_mask:0xf bank_mask:0xf
    v_mfma_f32_16x16x32_bf16 v[172:175], v[108:111], a[64:67], v[172:175]
    v_cndmask_b32_dpp v19, v33, v35, vcc quad_perm:[2,3,0,1] row_mask:0xf bank_mask:0xf
    buffer_store_dwordx4 v[16:19], v114, s[12:15], 0 offen offset:0 sc1 nt
    v_mul_f32 v137, v137, v89
    v_mul_f32 v153, v153, v89
    v_cvt_pk_bf16_f32 v20, v137, v153
    v_mul_f32 v169, v169, v89
    v_mul_f32 v185, v185, v89
    v_cvt_pk_bf16_f32 v21, v169, v185
    v_mul_f32 v201, v201, v89
    v_mul_f32 v217, v217, v89
    v_cvt_pk_bf16_f32 v22, v201, v217
    v_mul_f32 v233, v233, v89
    v_mul_f32 v249, v249, v89
    v_cvt_pk_bf16_f32 v23, v233, v249
    v_mfma_f32_16x16x32_bf16 v[188:191], v[108:111], a[68:71], v[188:191]
    s_mov_b64 vcc, s[52:53]
    v_cndmask_b32_dpp v36, v21, v20, vcc quad_perm:[1,0,3,2] row_mask:0xf bank_mask:0xf
    v_cndmask_b32_dpp v38, v23, v22, vcc quad_perm:[1,0,3,2] row_mask:0xf bank_mask:0xf
    s_mov_b64 vcc, s[54:55]
    v_cndmask_b32_dpp v37, v20, v21, vcc quad_perm:[1,0,3,2] row_mask:0xf bank_mask:0xf
    v_cndmask_b32_dpp v39, v22, v23, vcc quad_perm:[1,0,3,2] row_mask:0xf bank_mask:0xf
    s_mov_b64 vcc, s[56:57]
    v_cndmask_b32_dpp v20, v38, v36, vcc quad_perm:[2,3,0,1] row_mask:0xf bank_mask:0xf
    v_cndmask_b32_dpp v21, v39, v37, vcc quad_perm:[2,3,0,1] row_mask:0xf bank_mask:0xf
    s_mov_b64 vcc, s[58:59]
    v_cndmask_b32_dpp v22, v36, v38, vcc quad_perm:[2,3,0,1] row_mask:0xf bank_mask:0xf
    v_cndmask_b32_dpp v23, v37, v39, vcc quad_perm:[2,3,0,1] row_mask:0xf bank_mask:0xf
    buffer_store_dwordx4 v[20:23], v114, s[12:15], 0 offen offset:256 sc1 nt
    v_mul_f32 v138, v138, v90
    v_mfma_f32_16x16x32_bf16 v[204:207], v[108:111], a[72:75], v[204:207]
    v_mul_f32 v154, v154, v90
    v_cvt_pk_bf16_f32 v24, v138, v154
    v_mul_f32 v170, v170, v90
    v_mul_f32 v186, v186, v90
    v_cvt_pk_bf16_f32 v25, v170, v186
    v_mul_f32 v202, v202, v90
    v_mul_f32 v218, v218, v90
    v_cvt_pk_bf16_f32 v26, v202, v218
    v_mul_f32 v234, v234, v90
    v_mul_f32 v250, v250, v90
    v_cvt_pk_bf16_f32 v27, v234, v250
    s_mov_b64 vcc, s[52:53]
    v_cndmask_b32_dpp v40, v25, v24, vcc quad_perm:[1,0,3,2] row_mask:0xf bank_mask:0xf
    v_cndmask_b32_dpp v42, v27, v26, vcc quad_perm:[1,0,3,2] row_mask:0xf bank_mask:0xf
    v_mfma_f32_16x16x32_bf16 v[220:223], v[108:111], a[76:79], v[220:223]
    s_mov_b64 vcc, s[54:55]
    v_cndmask_b32_dpp v41, v24, v25, vcc quad_perm:[1,0,3,2] row_mask:0xf bank_mask:0xf
    v_cndmask_b32_dpp v43, v26, v27, vcc quad_perm:[1,0,3,2] row_mask:0xf bank_mask:0xf
    s_mov_b64 vcc, s[56:57]
    v_cndmask_b32_dpp v24, v42, v40, vcc quad_perm:[2,3,0,1] row_mask:0xf bank_mask:0xf
    v_cndmask_b32_dpp v25, v43, v41, vcc quad_perm:[2,3,0,1] row_mask:0xf bank_mask:0xf
    s_mov_b64 vcc, s[58:59]
    v_cndmask_b32_dpp v26, v40, v42, vcc quad_perm:[2,3,0,1] row_mask:0xf bank_mask:0xf
    v_cndmask_b32_dpp v27, v41, v43, vcc quad_perm:[2,3,0,1] row_mask:0xf bank_mask:0xf
    buffer_store_dwordx4 v[24:27], v114, s[12:15], 0 offen offset:512 sc1 nt
    v_mul_f32 v139, v139, v91
    v_mul_f32 v155, v155, v91
    v_cvt_pk_bf16_f32 v28, v139, v155
    v_mul_f32 v171, v171, v91
    v_mfma_f32_16x16x32_bf16 v[236:239], v[108:111], a[80:83], v[236:239]
    v_mul_f32 v187, v187, v91
    v_cvt_pk_bf16_f32 v29, v171, v187
    v_mul_f32 v203, v203, v91
    v_mul_f32 v219, v219, v91
    v_cvt_pk_bf16_f32 v30, v203, v219
    v_mul_f32 v235, v235, v91
    v_mul_f32 v251, v251, v91
    v_cvt_pk_bf16_f32 v31, v235, v251
    s_mov_b64 vcc, s[52:53]
    v_cndmask_b32_dpp v44, v29, v28, vcc quad_perm:[1,0,3,2] row_mask:0xf bank_mask:0xf
    v_cndmask_b32_dpp v46, v31, v30, vcc quad_perm:[1,0,3,2] row_mask:0xf bank_mask:0xf
    s_mov_b64 vcc, s[54:55]
    v_cndmask_b32_dpp v45, v28, v29, vcc quad_perm:[1,0,3,2] row_mask:0xf bank_mask:0xf
    v_cndmask_b32_dpp v47, v30, v31, vcc quad_perm:[1,0,3,2] row_mask:0xf bank_mask:0xf
    v_mfma_f32_16x16x32_bf16 v[252:255], v[108:111], a[84:87], v[252:255]
    s_mov_b64 vcc, s[56:57]
    v_cndmask_b32_dpp v28, v46, v44, vcc quad_perm:[2,3,0,1] row_mask:0xf bank_mask:0xf
    v_cndmask_b32_dpp v29, v47, v45, vcc quad_perm:[2,3,0,1] row_mask:0xf bank_mask:0xf
    s_mov_b64 vcc, s[58:59]
    v_cndmask_b32_dpp v30, v44, v46, vcc quad_perm:[2,3,0,1] row_mask:0xf bank_mask:0xf
    v_cndmask_b32_dpp v31, v45, v47, vcc quad_perm:[2,3,0,1] row_mask:0xf bank_mask:0xf
    buffer_store_dwordx4 v[28:31], v114, s[12:15], 0 offen offset:768 sc1 nt
    s_waitcnt lgkmcnt(0)
    v_mul_f32 v140, v140, v92
    v_mul_f32 v156, v156, v92
    v_cvt_pk_bf16_f32 v48, v140, v156
    v_mul_f32 v172, v172, v92
    v_mul_f32 v188, v188, v92
    v_cvt_pk_bf16_f32 v49, v172, v188
    v_mul_f32 v204, v204, v92
    v_mul_f32 v220, v220, v92
    v_cvt_pk_bf16_f32 v50, v204, v220
    v_mul_f32 v236, v236, v92
    v_mul_f32 v252, v252, v92
    v_cvt_pk_bf16_f32 v51, v236, v252
    s_mov_b64 vcc, s[52:53]
    v_cndmask_b32_dpp v32, v49, v48, vcc quad_perm:[1,0,3,2] row_mask:0xf bank_mask:0xf
    v_cndmask_b32_dpp v34, v51, v50, vcc quad_perm:[1,0,3,2] row_mask:0xf bank_mask:0xf
    s_mov_b64 vcc, s[54:55]
    v_cndmask_b32_dpp v33, v48, v49, vcc quad_perm:[1,0,3,2] row_mask:0xf bank_mask:0xf
    v_cndmask_b32_dpp v35, v50, v51, vcc quad_perm:[1,0,3,2] row_mask:0xf bank_mask:0xf
    s_mov_b64 vcc, s[56:57]
    v_cndmask_b32_dpp v48, v34, v32, vcc quad_perm:[2,3,0,1] row_mask:0xf bank_mask:0xf
    v_cndmask_b32_dpp v49, v35, v33, vcc quad_perm:[2,3,0,1] row_mask:0xf bank_mask:0xf
    s_mov_b64 vcc, s[58:59]
    v_cndmask_b32_dpp v50, v32, v34, vcc quad_perm:[2,3,0,1] row_mask:0xf bank_mask:0xf
    v_cndmask_b32_dpp v51, v33, v35, vcc quad_perm:[2,3,0,1] row_mask:0xf bank_mask:0xf
    buffer_store_dwordx4 v[48:51], v115, s[12:15], 0 offen offset:0 sc1 nt
    v_mul_f32 v141, v141, v93
    v_mul_f32 v157, v157, v93
    v_cvt_pk_bf16_f32 v52, v141, v157
    v_mul_f32 v173, v173, v93
    v_mul_f32 v189, v189, v93
    v_cvt_pk_bf16_f32 v53, v173, v189
    v_mul_f32 v205, v205, v93
    v_mul_f32 v221, v221, v93
    v_cvt_pk_bf16_f32 v54, v205, v221
    v_mul_f32 v237, v237, v93
    v_mul_f32 v253, v253, v93
    v_cvt_pk_bf16_f32 v55, v237, v253
    s_mov_b64 vcc, s[52:53]
    v_cndmask_b32_dpp v36, v53, v52, vcc quad_perm:[1,0,3,2] row_mask:0xf bank_mask:0xf
    v_cndmask_b32_dpp v38, v55, v54, vcc quad_perm:[1,0,3,2] row_mask:0xf bank_mask:0xf
    s_mov_b64 vcc, s[54:55]
    v_cndmask_b32_dpp v37, v52, v53, vcc quad_perm:[1,0,3,2] row_mask:0xf bank_mask:0xf
    v_cndmask_b32_dpp v39, v54, v55, vcc quad_perm:[1,0,3,2] row_mask:0xf bank_mask:0xf
    s_mov_b64 vcc, s[56:57]
    v_cndmask_b32_dpp v52, v38, v36, vcc quad_perm:[2,3,0,1] row_mask:0xf bank_mask:0xf
    v_cndmask_b32_dpp v53, v39, v37, vcc quad_perm:[2,3,0,1] row_mask:0xf bank_mask:0xf
    s_mov_b64 vcc, s[58:59]
    v_cndmask_b32_dpp v54, v36, v38, vcc quad_perm:[2,3,0,1] row_mask:0xf bank_mask:0xf
    v_cndmask_b32_dpp v55, v37, v39, vcc quad_perm:[2,3,0,1] row_mask:0xf bank_mask:0xf
    buffer_store_dwordx4 v[52:55], v115, s[12:15], 0 offen offset:256 sc1 nt
    v_mul_f32 v142, v142, v94
    v_mul_f32 v158, v158, v94
    v_cvt_pk_bf16_f32 v56, v142, v158
    v_mul_f32 v174, v174, v94
    v_mul_f32 v190, v190, v94
    v_cvt_pk_bf16_f32 v57, v174, v190
    v_mul_f32 v206, v206, v94
    v_mul_f32 v222, v222, v94
    v_cvt_pk_bf16_f32 v58, v206, v222
    v_mul_f32 v238, v238, v94
    v_mul_f32 v254, v254, v94
    v_cvt_pk_bf16_f32 v59, v238, v254
    s_mov_b64 vcc, s[52:53]
    v_cndmask_b32_dpp v40, v57, v56, vcc quad_perm:[1,0,3,2] row_mask:0xf bank_mask:0xf
    v_cndmask_b32_dpp v42, v59, v58, vcc quad_perm:[1,0,3,2] row_mask:0xf bank_mask:0xf
    s_mov_b64 vcc, s[54:55]
    v_cndmask_b32_dpp v41, v56, v57, vcc quad_perm:[1,0,3,2] row_mask:0xf bank_mask:0xf
    v_cndmask_b32_dpp v43, v58, v59, vcc quad_perm:[1,0,3,2] row_mask:0xf bank_mask:0xf
    s_mov_b64 vcc, s[56:57]
    v_cndmask_b32_dpp v56, v42, v40, vcc quad_perm:[2,3,0,1] row_mask:0xf bank_mask:0xf
    v_cndmask_b32_dpp v57, v43, v41, vcc quad_perm:[2,3,0,1] row_mask:0xf bank_mask:0xf
    s_mov_b64 vcc, s[58:59]
    v_cndmask_b32_dpp v58, v40, v42, vcc quad_perm:[2,3,0,1] row_mask:0xf bank_mask:0xf
    v_cndmask_b32_dpp v59, v41, v43, vcc quad_perm:[2,3,0,1] row_mask:0xf bank_mask:0xf
    buffer_store_dwordx4 v[56:59], v115, s[12:15], 0 offen offset:512 sc1 nt
    v_mul_f32 v143, v143, v95
    v_mul_f32 v159, v159, v95
    v_cvt_pk_bf16_f32 v60, v143, v159
    v_mul_f32 v175, v175, v95
    v_mul_f32 v191, v191, v95
    v_cvt_pk_bf16_f32 v61, v175, v191
    v_mul_f32 v207, v207, v95
    v_mul_f32 v223, v223, v95
    v_cvt_pk_bf16_f32 v62, v207, v223
    v_mul_f32 v239, v239, v95
    v_mul_f32 v255, v255, v95
    v_cvt_pk_bf16_f32 v63, v239, v255
    s_mov_b64 vcc, s[52:53]
    v_cndmask_b32_dpp v44, v61, v60, vcc quad_perm:[1,0,3,2] row_mask:0xf bank_mask:0xf
    v_cndmask_b32_dpp v46, v63, v62, vcc quad_perm:[1,0,3,2] row_mask:0xf bank_mask:0xf
    s_mov_b64 vcc, s[54:55]
    v_cndmask_b32_dpp v45, v60, v61, vcc quad_perm:[1,0,3,2] row_mask:0xf bank_mask:0xf
    v_cndmask_b32_dpp v47, v62, v63, vcc quad_perm:[1,0,3,2] row_mask:0xf bank_mask:0xf
    s_mov_b64 vcc, s[56:57]
    v_cndmask_b32_dpp v60, v46, v44, vcc quad_perm:[2,3,0,1] row_mask:0xf bank_mask:0xf
    v_cndmask_b32_dpp v61, v47, v45, vcc quad_perm:[2,3,0,1] row_mask:0xf bank_mask:0xf
    s_mov_b64 vcc, s[58:59]
    v_cndmask_b32_dpp v62, v44, v46, vcc quad_perm:[2,3,0,1] row_mask:0xf bank_mask:0xf
    v_cndmask_b32_dpp v63, v45, v47, vcc quad_perm:[2,3,0,1] row_mask:0xf bank_mask:0xf
    buffer_store_dwordx4 v[60:63], v115, s[12:15], 0 offen offset:768 sc1 nt
    s_branch M_done
M_fin:
    v_and_b32 v112, 15, v0
    v_lshlrev_b32 v112, 8, v112
    v_lshrrev_b32 v113, 4, v0
    v_lshl_add_u32 v112, v113, 4, v112
    v_add_u32 v113, 4096, v112
    v_add_u32 v114, 8192, v112
    v_add_u32 v115, 12288, v112
    v_rcp_f32 v8, v4
    v_rcp_f32 v9, v5
    v_rcp_f32 v10, v6
    v_rcp_f32 v11, v7
    s_nop 0
    v_fma_f32 v12, -v4, v8, 2.0
    v_fma_f32 v13, -v5, v9, 2.0
    v_fma_f32 v14, -v6, v10, 2.0
    v_fma_f32 v15, -v7, v11, 2.0
    v_mul_f32 v8, v8, v12
    v_mul_f32 v9, v9, v13
    v_mul_f32 v10, v10, v14
    v_mul_f32 v11, v11, v15
    v_mul_f32 v128, v128, v8
    v_mul_f32 v144, v144, v8
    v_cvt_pk_bf16_f32 v16, v128, v144
    v_mul_f32 v129, v129, v8
    v_mul_f32 v145, v145, v8
    v_cvt_pk_bf16_f32 v17, v129, v145
    v_mul_f32 v130, v130, v8
    v_mul_f32 v146, v146, v8
    v_cvt_pk_bf16_f32 v18, v130, v146
    v_mul_f32 v131, v131, v8
    v_mul_f32 v147, v147, v8
    v_cvt_pk_bf16_f32 v19, v131, v147
    buffer_store_dwordx4 v[16:19], v112, s[12:15], 0 offen offset:0 sc1 nt
    v_mul_f32 v160, v160, v8
    v_mul_f32 v176, v176, v8
    v_cvt_pk_bf16_f32 v20, v160, v176
    v_mul_f32 v161, v161, v8
    v_mul_f32 v177, v177, v8
    v_cvt_pk_bf16_f32 v21, v161, v177
    v_mul_f32 v162, v162, v8
    v_mul_f32 v178, v178, v8
    v_cvt_pk_bf16_f32 v22, v162, v178
    v_mul_f32 v163, v163, v8
    v_mul_f32 v179, v179, v8
    v_cvt_pk_bf16_f32 v23, v163, v179
    buffer_store_dwordx4 v[20:23], v112, s[12:15], 0 offen offset:64 sc1 nt
    v_mul_f32 v192, v192, v8
    v_mul_f32 v208, v208, v8
    v_cvt_pk_bf16_f32 v32, v192, v208
    v_mul_f32 v193, v193, v8
    v_mul_f32 v209, v209, v8
    v_cvt_pk_bf16_f32 v33, v193, v209
    v_mul_f32 v194, v194, v8
    v_mul_f32 v210, v210, v8
    v_cvt_pk_bf16_f32 v34, v194, v210
    v_mul_f32 v195, v195, v8
    v_mul_f32 v211, v211, v8
    v_cvt_pk_bf16_f32 v35, v195, v211
    buffer_store_dwordx4 v[32:35], v112, s[12:15], 0 offen offset:128 sc1 nt
    v_mul_f32 v224, v224, v8
    v_mul_f32 v240, v240, v8
    v_cvt_pk_bf16_f32 v36, v224, v240
    v_mul_f32 v225, v225, v8
    v_mul_f32 v241, v241, v8
    v_cvt_pk_bf16_f32 v37, v225, v241
    v_mul_f32 v226, v226, v8
    v_mul_f32 v242, v242, v8
    v_cvt_pk_bf16_f32 v38, v226, v242
    v_mul_f32 v227, v227, v8
    v_mul_f32 v243, v243, v8
    v_cvt_pk_bf16_f32 v39, v227, v243
    buffer_store_dwordx4 v[36:39], v112, s[12:15], 0 offen offset:192 sc1 nt
    v_mul_f32 v132, v132, v9
    v_mul_f32 v148, v148, v9
    v_cvt_pk_bf16_f32 v48, v132, v148
    v_mul_f32 v133, v133, v9
    v_mul_f32 v149, v149, v9
    v_cvt_pk_bf16_f32 v49, v133, v149
    v_mul_f32 v134, v134, v9
    v_mul_f32 v150, v150, v9
    v_cvt_pk_bf16_f32 v50, v134, v150
    v_mul_f32 v135, v135, v9
    v_mul_f32 v151, v151, v9
    v_cvt_pk_bf16_f32 v51, v135, v151
    buffer_store_dwordx4 v[48:51], v113, s[12:15], 0 offen offset:0 sc1 nt
    v_mul_f32 v164, v164, v9
    v_mul_f32 v180, v180, v9
    v_cvt_pk_bf16_f32 v52, v164, v180
    v_mul_f32 v165, v165, v9
    v_mul_f32 v181, v181, v9
    v_cvt_pk_bf16_f32 v53, v165, v181
    v_mul_f32 v166, v166, v9
    v_mul_f32 v182, v182, v9
    v_cvt_pk_bf16_f32 v54, v166, v182
    v_mul_f32 v167, v167, v9
    v_mul_f32 v183, v183, v9
    v_cvt_pk_bf16_f32 v55, v167, v183
    buffer_store_dwordx4 v[52:55], v113, s[12:15], 0 offen offset:64 sc1 nt
    v_mul_f32 v196, v196, v9
    v_mul_f32 v212, v212, v9
    v_cvt_pk_bf16_f32 v64, v196, v212
    v_mul_f32 v197, v197, v9
    v_mul_f32 v213, v213, v9
    v_cvt_pk_bf16_f32 v65, v197, v213
    v_mul_f32 v198, v198, v9
    v_mul_f32 v214, v214, v9
    v_cvt_pk_bf16_f32 v66, v198, v214
    v_mul_f32 v199, v199, v9
    v_mul_f32 v215, v215, v9
    v_cvt_pk_bf16_f32 v67, v199, v215
    buffer_store_dwordx4 v[64:67], v113, s[12:15], 0 offen offset:128 sc1 nt
    v_mul_f32 v228, v228, v9
    v_mul_f32 v244, v244, v9
    v_cvt_pk_bf16_f32 v68, v228, v244
    v_mul_f32 v229, v229, v9
    v_mul_f32 v245, v245, v9
    v_cvt_pk_bf16_f32 v69, v229, v245
    v_mul_f32 v230, v230, v9
    v_mul_f32 v246, v246, v9
    v_cvt_pk_bf16_f32 v70, v230, v246
    v_mul_f32 v231, v231, v9
    v_mul_f32 v247, v247, v9
    v_cvt_pk_bf16_f32 v71, v231, v247
    buffer_store_dwordx4 v[68:71], v113, s[12:15], 0 offen offset:192 sc1 nt
    v_mul_f32 v136, v136, v10
    v_mul_f32 v152, v152, v10
    v_cvt_pk_bf16_f32 v16, v136, v152
    v_mul_f32 v137, v137, v10
    v_mul_f32 v153, v153, v10
    v_cvt_pk_bf16_f32 v17, v137, v153
    v_mul_f32 v138, v138, v10
    v_mul_f32 v154, v154, v10
    v_cvt_pk_bf16_f32 v18, v138, v154
    v_mul_f32 v139, v139, v10
    v_mul_f32 v155, v155, v10
    v_cvt_pk_bf16_f32 v19, v139, v155
    buffer_store_dwordx4 v[16:19], v114, s[12:15], 0 offen offset:0 sc1 nt
    v_mul_f32 v168, v168, v10
    v_mul_f32 v184, v184, v10
    v_cvt_pk_bf16_f32 v20, v168, v184
    v_mul_f32 v169, v169, v10
    v_mul_f32 v185, v185, v10
    v_cvt_pk_bf16_f32 v21, v169, v185
    v_mul_f32 v170, v170, v10
    v_mul_f32 v186, v186, v10
    v_cvt_pk_bf16_f32 v22, v170, v186
    v_mul_f32 v171, v171, v10
    v_mul_f32 v187, v187, v10
    v_cvt_pk_bf16_f32 v23, v171, v187
    buffer_store_dwordx4 v[20:23], v114, s[12:15], 0 offen offset:64 sc1 nt
    v_mul_f32 v200, v200, v10
    v_mul_f32 v216, v216, v10
    v_cvt_pk_bf16_f32 v32, v200, v216
    v_mul_f32 v201, v201, v10
    v_mul_f32 v217, v217, v10
    v_cvt_pk_bf16_f32 v33, v201, v217
    v_mul_f32 v202, v202, v10
    v_mul_f32 v218, v218, v10
    v_cvt_pk_bf16_f32 v34, v202, v218
    v_mul_f32 v203, v203, v10
    v_mul_f32 v219, v219, v10
    v_cvt_pk_bf16_f32 v35, v203, v219
    buffer_store_dwordx4 v[32:35], v114, s[12:15], 0 offen offset:128 sc1 nt
    v_mul_f32 v232, v232, v10
    v_mul_f32 v248, v248, v10
    v_cvt_pk_bf16_f32 v36, v232, v248
    v_mul_f32 v233, v233, v10
    v_mul_f32 v249, v249, v10
    v_cvt_pk_bf16_f32 v37, v233, v249
    v_mul_f32 v234, v234, v10
    v_mul_f32 v250, v250, v10
    v_cvt_pk_bf16_f32 v38, v234, v250
    v_mul_f32 v235, v235, v10
    v_mul_f32 v251, v251, v10
    v_cvt_pk_bf16_f32 v39, v235, v251
    buffer_store_dwordx4 v[36:39], v114, s[12:15], 0 offen offset:192 sc1 nt
    v_mul_f32 v140, v140, v11
    v_mul_f32 v156, v156, v11
    v_cvt_pk_bf16_f32 v48, v140, v156
    v_mul_f32 v141, v141, v11
    v_mul_f32 v157, v157, v11
    v_cvt_pk_bf16_f32 v49, v141, v157
    v_mul_f32 v142, v142, v11
    v_mul_f32 v158, v158, v11
    v_cvt_pk_bf16_f32 v50, v142, v158
    v_mul_f32 v143, v143, v11
    v_mul_f32 v159, v159, v11
    v_cvt_pk_bf16_f32 v51, v143, v159
    buffer_store_dwordx4 v[48:51], v115, s[12:15], 0 offen offset:0 sc1 nt
    v_mul_f32 v172, v172, v11
    v_mul_f32 v188, v188, v11
    v_cvt_pk_bf16_f32 v52, v172, v188
    v_mul_f32 v173, v173, v11
    v_mul_f32 v189, v189, v11
    v_cvt_pk_bf16_f32 v53, v173, v189
    v_mul_f32 v174, v174, v11
    v_mul_f32 v190, v190, v11
    v_cvt_pk_bf16_f32 v54, v174, v190
    v_mul_f32 v175, v175, v11
    v_mul_f32 v191, v191, v11
    v_cvt_pk_bf16_f32 v55, v175, v191
    buffer_store_dwordx4 v[52:55], v115, s[12:15], 0 offen offset:64 sc1 nt
    v_mul_f32 v204, v204, v11
    v_mul_f32 v220, v220, v11
    v_cvt_pk_bf16_f32 v64, v204, v220
    v_mul_f32 v205, v205, v11
    v_mul_f32 v221, v221, v11
    v_cvt_pk_bf16_f32 v65, v205, v221
    v_mul_f32 v206, v206, v11
    v_mul_f32 v222, v222, v11
    v_cvt_pk_bf16_f32 v66, v206, v222
    v_mul_f32 v207, v207, v11
    v_mul_f32 v223, v223, v11
    v_cvt_pk_bf16_f32 v67, v207, v223
    buffer_store_dwordx4 v[64:67], v115, s[12:15], 0 offen offset:128 sc1 nt
    v_mul_f32 v236, v236, v11
    v_mul_f32 v252, v252, v11
    v_cvt_pk_bf16_f32 v68, v236, v252
    v_mul_f32 v237, v237, v11
    v_mul_f32 v253, v253, v11
    v_cvt_pk_bf16_f32 v69, v237, v253
    v_mul_f32 v238, v238, v11
    v_mul_f32 v254, v254, v11
    v_cvt_pk_bf16_f32 v70, v238, v254
    v_mul_f32 v239, v239, v11
    v_mul_f32 v255, v255, v11
    v_cvt_pk_bf16_f32 v71, v239, v255
    buffer_store_dwordx4 v[68:71], v115, s[12:15], 0 offen offset:192 sc1 nt
M_done:
M_end:
    s_endpgm
M_fallback:
    v_and_b32 v240, 15, v0
    v_lshrrev_b32 v241, 4, v0
    s_mov_b32 s19, 0
M_fb_loop:
    s_lshr_b32 s62, s19, 2
    s_and_b32 s63, s19, 3
    s_lshl_b32 s56, s63, 7
    v_lshlrev_b32 v242, 9, v240
    v_lshl_add_u32 v242, v241, 5, v242
    v_add_u32 v242, s56, v242
    s_lshl_b32 s57, s63, 6
    v_lshlrev_b32 v243, 4, v241
    v_add_u32 v243, s57, v243
    v_lshlrev_b32 v244, 11, v241
    v_lshl_add_u32 v244, v240, 3, v244
    v_add_u32 v244, s56, v244
    v_lshlrev_b32 v245, 3, v241
    s_lshl_b32 s64, s62, 14
    s_add_u32 s65, s64, 0x2000
    s_lshr_b32 s66, s62, 5
    s_lshl_b32 s66, s66, 8
    buffer_load_dwordx4 v[128:131], v242, s[20:23], s64 offen offset:0
    buffer_load_dwordx4 v[132:135], v242, s[20:23], s64 offen offset:16
    buffer_load_dwordx4 v[136:139], v242, s[20:23], s65 offen offset:0
    buffer_load_dwordx4 v[140:143], v242, s[20:23], s65 offen offset:16
    buffer_load_dwordx4 v[144:147], v243, s[28:31], s66 offen
    buffer_load_dwordx4 v[148:151], v243, s[32:35], s66 offen
    s_lshl_b32 s64, s62, 14
    s_add_u32 s65, s64, 0x2000
    s_lshl_b32 s66, s62, 6
    buffer_load_dwordx2 v[152:153], v244, s[24:27], s64 offen offset:0 nt
    buffer_load_dwordx2 v[154:155], v244, s[24:27], s64 offen offset:512 nt
    buffer_load_dwordx2 v[156:157], v244, s[24:27], s64 offen offset:1024 nt
    buffer_load_dwordx2 v[158:159], v244, s[24:27], s64 offen offset:1536 nt
    buffer_load_dwordx2 v[160:161], v244, s[24:27], s65 offen offset:0 nt
    buffer_load_dwordx2 v[162:163], v244, s[24:27], s65 offen offset:512 nt
    buffer_load_dwordx2 v[164:165], v244, s[24:27], s65 offen offset:1024 nt
    buffer_load_dwordx2 v[166:167], v244, s[24:27], s65 offen offset:1536 nt
    buffer_load_dwordx2 v[168:169], v245, s[36:39], s66 offen offset:0
    buffer_load_dwordx2 v[170:171], v245, s[36:39], s66 offen offset:32
    buffer_load_dwordx2 v[172:173], v245, s[40:43], s66 offen offset:0
    buffer_load_dwordx2 v[174:175], v245, s[40:43], s66 offen offset:32
    s_waitcnt vmcnt(0)
    v_lshlrev_b32 v176, 16, v144
    v_and_b32 v177, s51, v144
    v_lshlrev_b32 v184, 16, v148
    v_and_b32 v185, s51, v148
    v_lshlrev_b32 v178, 16, v145
    v_and_b32 v179, s51, v145
    v_lshlrev_b32 v186, 16, v149
    v_and_b32 v187, s51, v149
    v_lshlrev_b32 v180, 16, v146
    v_and_b32 v181, s51, v146
    v_lshlrev_b32 v188, 16, v150
    v_and_b32 v189, s51, v150
    v_lshlrev_b32 v182, 16, v147
    v_and_b32 v183, s51, v147
    v_lshlrev_b32 v190, 16, v151
    v_and_b32 v191, s51, v151
    v_cvt_f32_i32 v128, v128
    v_cvt_f32_i32 v129, v129
    v_cvt_pk_bf16_f32 v192, v128, v129
    v_lshlrev_b32 v128, 16, v192
    v_and_b32 v129, s51, v192
    v_sub_f32 v128, v128, v184
    v_sub_f32 v129, v129, v185
    v_cvt_pk_bf16_f32 v192, v128, v129
    v_lshlrev_b32 v128, 16, v192
    v_and_b32 v129, s51, v192
    v_mul_f32 v128, v128, v176
    v_mul_f32 v129, v129, v177
    v_cvt_pk_bf16_f32 v192, v128, v129
    v_lshlrev_b32 v128, 16, v192
    v_and_b32 v129, s51, v192
    v_mul_f32 v128, s50, v128
    v_mul_f32 v129, s50, v129
    v_cvt_pk_bf16_f32 v200, v128, v129
    v_cvt_f32_i32 v130, v130
    v_cvt_f32_i32 v131, v131
    v_cvt_pk_bf16_f32 v192, v130, v131
    v_lshlrev_b32 v130, 16, v192
    v_and_b32 v131, s51, v192
    v_sub_f32 v130, v130, v186
    v_sub_f32 v131, v131, v187
    v_cvt_pk_bf16_f32 v192, v130, v131
    v_lshlrev_b32 v130, 16, v192
    v_and_b32 v131, s51, v192
    v_mul_f32 v130, v130, v178
    v_mul_f32 v131, v131, v179
    v_cvt_pk_bf16_f32 v192, v130, v131
    v_lshlrev_b32 v130, 16, v192
    v_and_b32 v131, s51, v192
    v_mul_f32 v130, s50, v130
    v_mul_f32 v131, s50, v131
    v_cvt_pk_bf16_f32 v201, v130, v131
    v_cvt_f32_i32 v132, v132
    v_cvt_f32_i32 v133, v133
    v_cvt_pk_bf16_f32 v192, v132, v133
    v_lshlrev_b32 v132, 16, v192
    v_and_b32 v133, s51, v192
    v_sub_f32 v132, v132, v188
    v_sub_f32 v133, v133, v189
    v_cvt_pk_bf16_f32 v192, v132, v133
    v_lshlrev_b32 v132, 16, v192
    v_and_b32 v133, s51, v192
    v_mul_f32 v132, v132, v180
    v_mul_f32 v133, v133, v181
    v_cvt_pk_bf16_f32 v192, v132, v133
    v_lshlrev_b32 v132, 16, v192
    v_and_b32 v133, s51, v192
    v_mul_f32 v132, s50, v132
    v_mul_f32 v133, s50, v133
    v_cvt_pk_bf16_f32 v202, v132, v133
    v_cvt_f32_i32 v134, v134
    v_cvt_f32_i32 v135, v135
    v_cvt_pk_bf16_f32 v192, v134, v135
    v_lshlrev_b32 v134, 16, v192
    v_and_b32 v135, s51, v192
    v_sub_f32 v134, v134, v190
    v_sub_f32 v135, v135, v191
    v_cvt_pk_bf16_f32 v192, v134, v135
    v_lshlrev_b32 v134, 16, v192
    v_and_b32 v135, s51, v192
    v_mul_f32 v134, v134, v182
    v_mul_f32 v135, v135, v183
    v_cvt_pk_bf16_f32 v192, v134, v135
    v_lshlrev_b32 v134, 16, v192
    v_and_b32 v135, s51, v192
    v_mul_f32 v134, s50, v134
    v_mul_f32 v135, s50, v135
    v_cvt_pk_bf16_f32 v203, v134, v135
    v_cvt_f32_i32 v136, v136
    v_cvt_f32_i32 v137, v137
    v_cvt_pk_bf16_f32 v192, v136, v137
    v_lshlrev_b32 v136, 16, v192
    v_and_b32 v137, s51, v192
    v_sub_f32 v136, v136, v184
    v_sub_f32 v137, v137, v185
    v_cvt_pk_bf16_f32 v192, v136, v137
    v_lshlrev_b32 v136, 16, v192
    v_and_b32 v137, s51, v192
    v_mul_f32 v136, v136, v176
    v_mul_f32 v137, v137, v177
    v_cvt_pk_bf16_f32 v192, v136, v137
    v_lshlrev_b32 v136, 16, v192
    v_and_b32 v137, s51, v192
    v_mul_f32 v136, s50, v136
    v_mul_f32 v137, s50, v137
    v_cvt_pk_bf16_f32 v204, v136, v137
    v_cvt_f32_i32 v138, v138
    v_cvt_f32_i32 v139, v139
    v_cvt_pk_bf16_f32 v192, v138, v139
    v_lshlrev_b32 v138, 16, v192
    v_and_b32 v139, s51, v192
    v_sub_f32 v138, v138, v186
    v_sub_f32 v139, v139, v187
    v_cvt_pk_bf16_f32 v192, v138, v139
    v_lshlrev_b32 v138, 16, v192
    v_and_b32 v139, s51, v192
    v_mul_f32 v138, v138, v178
    v_mul_f32 v139, v139, v179
    v_cvt_pk_bf16_f32 v192, v138, v139
    v_lshlrev_b32 v138, 16, v192
    v_and_b32 v139, s51, v192
    v_mul_f32 v138, s50, v138
    v_mul_f32 v139, s50, v139
    v_cvt_pk_bf16_f32 v205, v138, v139
    v_cvt_f32_i32 v140, v140
    v_cvt_f32_i32 v141, v141
    v_cvt_pk_bf16_f32 v192, v140, v141
    v_lshlrev_b32 v140, 16, v192
    v_and_b32 v141, s51, v192
    v_sub_f32 v140, v140, v188
    v_sub_f32 v141, v141, v189
    v_cvt_pk_bf16_f32 v192, v140, v141
    v_lshlrev_b32 v140, 16, v192
    v_and_b32 v141, s51, v192
    v_mul_f32 v140, v140, v180
    v_mul_f32 v141, v141, v181
    v_cvt_pk_bf16_f32 v192, v140, v141
    v_lshlrev_b32 v140, 16, v192
    v_and_b32 v141, s51, v192
    v_mul_f32 v140, s50, v140
    v_mul_f32 v141, s50, v141
    v_cvt_pk_bf16_f32 v206, v140, v141
    v_cvt_f32_i32 v142, v142
    v_cvt_f32_i32 v143, v143
    v_cvt_pk_bf16_f32 v192, v142, v143
    v_lshlrev_b32 v142, 16, v192
    v_and_b32 v143, s51, v192
    v_sub_f32 v142, v142, v190
    v_sub_f32 v143, v143, v191
    v_cvt_pk_bf16_f32 v192, v142, v143
    v_lshlrev_b32 v142, 16, v192
    v_and_b32 v143, s51, v192
    v_mul_f32 v142, v142, v182
    v_mul_f32 v143, v143, v183
    v_cvt_pk_bf16_f32 v192, v142, v143
    v_lshlrev_b32 v142, 16, v192
    v_and_b32 v143, s51, v192
    v_mul_f32 v142, s50, v142
    v_mul_f32 v143, s50, v143
    v_cvt_pk_bf16_f32 v207, v142, v143
    v_lshlrev_b32 v176, 16, v168
    v_and_b32 v177, s51, v168
    v_lshlrev_b32 v184, 16, v172
    v_and_b32 v185, s51, v172
    v_lshlrev_b32 v178, 16, v169
    v_and_b32 v179, s51, v169
    v_lshlrev_b32 v186, 16, v173
    v_and_b32 v187, s51, v173
    v_lshlrev_b32 v180, 16, v170
    v_and_b32 v181, s51, v170
    v_lshlrev_b32 v188, 16, v174
    v_and_b32 v189, s51, v174
    v_lshlrev_b32 v182, 16, v171
    v_and_b32 v183, s51, v171
    v_lshlrev_b32 v190, 16, v175
    v_and_b32 v191, s51, v175
    v_cvt_f32_i32 v152, v152
    v_cvt_f32_i32 v154, v154
    v_cvt_pk_bf16_f32 v192, v152, v154
    v_lshlrev_b32 v152, 16, v192
    v_and_b32 v154, s51, v192
    v_sub_f32 v152, v152, v184
    v_sub_f32 v154, v154, v185
    v_cvt_pk_bf16_f32 v192, v152, v154
    v_lshlrev_b32 v152, 16, v192
    v_and_b32 v154, s51, v192
    v_mul_f32 v152, v152, v176
    v_mul_f32 v154, v154, v177
    v_cvt_pk_bf16_f32 v208, v152, v154
    v_cvt_f32_i32 v156, v156
    v_cvt_f32_i32 v158, v158
    v_cvt_pk_bf16_f32 v192, v156, v158
    v_lshlrev_b32 v156, 16, v192
    v_and_b32 v158, s51, v192
    v_sub_f32 v156, v156, v186
    v_sub_f32 v158, v158, v187
    v_cvt_pk_bf16_f32 v192, v156, v158
    v_lshlrev_b32 v156, 16, v192
    v_and_b32 v158, s51, v192
    v_mul_f32 v156, v156, v178
    v_mul_f32 v158, v158, v179
    v_cvt_pk_bf16_f32 v209, v156, v158
    v_cvt_f32_i32 v160, v160
    v_cvt_f32_i32 v162, v162
    v_cvt_pk_bf16_f32 v192, v160, v162
    v_lshlrev_b32 v160, 16, v192
    v_and_b32 v162, s51, v192
    v_sub_f32 v160, v160, v188
    v_sub_f32 v162, v162, v189
    v_cvt_pk_bf16_f32 v192, v160, v162
    v_lshlrev_b32 v160, 16, v192
    v_and_b32 v162, s51, v192
    v_mul_f32 v160, v160, v180
    v_mul_f32 v162, v162, v181
    v_cvt_pk_bf16_f32 v210, v160, v162
    v_cvt_f32_i32 v164, v164
    v_cvt_f32_i32 v166, v166
    v_cvt_pk_bf16_f32 v192, v164, v166
    v_lshlrev_b32 v164, 16, v192
    v_and_b32 v166, s51, v192
    v_sub_f32 v164, v164, v190
    v_sub_f32 v166, v166, v191
    v_cvt_pk_bf16_f32 v192, v164, v166
    v_lshlrev_b32 v164, 16, v192
    v_and_b32 v166, s51, v192
    v_mul_f32 v164, v164, v182
    v_mul_f32 v166, v166, v183
    v_cvt_pk_bf16_f32 v211, v164, v166
    v_cvt_f32_i32 v153, v153
    v_cvt_f32_i32 v155, v155
    v_cvt_pk_bf16_f32 v192, v153, v155
    v_lshlrev_b32 v153, 16, v192
    v_and_b32 v155, s51, v192
    v_sub_f32 v153, v153, v184
    v_sub_f32 v155, v155, v185
    v_cvt_pk_bf16_f32 v192, v153, v155
    v_lshlrev_b32 v153, 16, v192
    v_and_b32 v155, s51, v192
    v_mul_f32 v153, v153, v176
    v_mul_f32 v155, v155, v177
    v_cvt_pk_bf16_f32 v212, v153, v155
    v_cvt_f32_i32 v157, v157
    v_cvt_f32_i32 v159, v159
    v_cvt_pk_bf16_f32 v192, v157, v159
    v_lshlrev_b32 v157, 16, v192
    v_and_b32 v159, s51, v192
    v_sub_f32 v157, v157, v186
    v_sub_f32 v159, v159, v187
    v_cvt_pk_bf16_f32 v192, v157, v159
    v_lshlrev_b32 v157, 16, v192
    v_and_b32 v159, s51, v192
    v_mul_f32 v157, v157, v178
    v_mul_f32 v159, v159, v179
    v_cvt_pk_bf16_f32 v213, v157, v159
    v_cvt_f32_i32 v161, v161
    v_cvt_f32_i32 v163, v163
    v_cvt_pk_bf16_f32 v192, v161, v163
    v_lshlrev_b32 v161, 16, v192
    v_and_b32 v163, s51, v192
    v_sub_f32 v161, v161, v188
    v_sub_f32 v163, v163, v189
    v_cvt_pk_bf16_f32 v192, v161, v163
    v_lshlrev_b32 v161, 16, v192
    v_and_b32 v163, s51, v192
    v_mul_f32 v161, v161, v180
    v_mul_f32 v163, v163, v181
    v_cvt_pk_bf16_f32 v214, v161, v163
    v_cvt_f32_i32 v165, v165
    v_cvt_f32_i32 v167, v167
    v_cvt_pk_bf16_f32 v192, v165, v167
    v_lshlrev_b32 v165, 16, v192
    v_and_b32 v167, s51, v192
    v_sub_f32 v165, v165, v190
    v_sub_f32 v167, v167, v191
    v_cvt_pk_bf16_f32 v192, v165, v167
    v_lshlrev_b32 v165, 16, v192
    v_and_b32 v167, s51, v192
    v_mul_f32 v165, v165, v182
    v_mul_f32 v167, v167, v183
    v_cvt_pk_bf16_f32 v215, v165, v167
    s_add_u32 s64, s62, 62
    s_and_b32 s64, s64, 63
    s_lshl_b32 s64, s64, 14
    s_lshl_b32 s65, s63, 10
    s_add_u32 s64, s64, s65
    s_add_u32 s66, s64, 0x1000
    s_lshl_b32 s67, s62, 14
    s_add_u32 s67, s67, 0x2000
    s_add_u32 s67, s67, s65
    s_add_u32 s67, s67, s65
    buffer_store_dwordx4 v[200:203], v1, s[8:11], s64 offen sc1
    buffer_store_dwordx4 v[204:207], v1, s[8:11], s66 offen sc1
    buffer_store_dwordx4 v[208:211], v1, s[8:11], s67 offen sc1
    buffer_store_dwordx4 v[212:215], v1, s[8:11], s67 offen offset:1024 sc1
    s_waitcnt vmcnt(0)
    s_add_u32 s19, s19, 1
    s_cmp_lt_u32 s19, 256
    s_cbranch_scc1 M_fb_loop
    v_mov_b32 v128, 0
    v_mov_b32 v129, 0
    v_mov_b32 v130, 0
    v_mov_b32 v131, 0
    v_mov_b32 v132, 0
    v_mov_b32 v133, 0
    v_mov_b32 v134, 0
    v_mov_b32 v135, 0
    v_mov_b32 v136, 0
    v_mov_b32 v137, 0
    v_mov_b32 v138, 0
    v_mov_b32 v139, 0
    v_mov_b32 v140, 0
    v_mov_b32 v141, 0
    v_mov_b32 v142, 0
    v_mov_b32 v143, 0
    v_mov_b32 v144, 0
    v_mov_b32 v145, 0
    v_mov_b32 v146, 0
    v_mov_b32 v147, 0
    v_mov_b32 v148, 0
    v_mov_b32 v149, 0
    v_mov_b32 v150, 0
    v_mov_b32 v151, 0
    v_mov_b32 v152, 0
    v_mov_b32 v153, 0
    v_mov_b32 v154, 0
    v_mov_b32 v155, 0
    v_mov_b32 v156, 0
    v_mov_b32 v157, 0
    v_mov_b32 v158, 0
    v_mov_b32 v159, 0
    v_mov_b32 v160, 0
    v_mov_b32 v161, 0
    v_mov_b32 v162, 0
    v_mov_b32 v163, 0
    v_mov_b32 v164, 0
    v_mov_b32 v165, 0
    v_mov_b32 v166, 0
    v_mov_b32 v167, 0
    v_mov_b32 v168, 0
    v_mov_b32 v169, 0
    v_mov_b32 v170, 0
    v_mov_b32 v171, 0
    v_mov_b32 v172, 0
    v_mov_b32 v173, 0
    v_mov_b32 v174, 0
    v_mov_b32 v175, 0
    v_mov_b32 v176, 0
    v_mov_b32 v177, 0
    v_mov_b32 v178, 0
    v_mov_b32 v179, 0
    v_mov_b32 v180, 0
    v_mov_b32 v181, 0
    v_mov_b32 v182, 0
    v_mov_b32 v183, 0
    v_mov_b32 v184, 0
    v_mov_b32 v185, 0
    v_mov_b32 v186, 0
    v_mov_b32 v187, 0
    v_mov_b32 v188, 0
    v_mov_b32 v189, 0
    v_mov_b32 v190, 0
    v_mov_b32 v191, 0
    v_mov_b32 v192, 0
    v_mov_b32 v193, 0
    v_mov_b32 v194, 0
    v_mov_b32 v195, 0
    v_mov_b32 v196, 0
    v_mov_b32 v197, 0
    v_mov_b32 v198, 0
    v_mov_b32 v199, 0
    v_mov_b32 v200, 0
    v_mov_b32 v201, 0
    v_mov_b32 v202, 0
    v_mov_b32 v203, 0
    v_mov_b32 v204, 0
    v_mov_b32 v205, 0
    v_mov_b32 v206, 0
    v_mov_b32 v207, 0
    v_mov_b32 v208, 0
    v_mov_b32 v209, 0
    v_mov_b32 v210, 0
    v_mov_b32 v211, 0
    v_mov_b32 v212, 0
    v_mov_b32 v213, 0
    v_mov_b32 v214, 0
    v_mov_b32 v215, 0
    v_mov_b32 v216, 0
    v_mov_b32 v217, 0
    v_mov_b32 v218, 0
    v_mov_b32 v219, 0
    v_mov_b32 v220, 0
    v_mov_b32 v221, 0
    v_mov_b32 v222, 0
    v_mov_b32 v223, 0
    v_mov_b32 v224, 0
    v_mov_b32 v225, 0
    v_mov_b32 v226, 0
    v_mov_b32 v227, 0
    v_mov_b32 v228, 0
    v_mov_b32 v229, 0
    v_mov_b32 v230, 0
    v_mov_b32 v231, 0
    v_mov_b32 v232, 0
    v_mov_b32 v233, 0
    v_mov_b32 v234, 0
    v_mov_b32 v235, 0
    v_mov_b32 v236, 0
    v_mov_b32 v237, 0
    v_mov_b32 v238, 0
    v_mov_b32 v239, 0
    v_mov_b32 v240, 0
    v_mov_b32 v241, 0
    v_mov_b32 v242, 0
    v_mov_b32 v243, 0
    v_mov_b32 v244, 0
    v_mov_b32 v245, 0
    v_mov_b32 v246, 0
    v_mov_b32 v247, 0
    v_mov_b32 v248, 0
    v_mov_b32 v249, 0
    v_mov_b32 v250, 0
    v_mov_b32 v251, 0
    v_mov_b32 v252, 0
    v_mov_b32 v253, 0
    v_mov_b32 v254, 0
    v_mov_b32 v255, 0
    s_branch M_ready
M_safe:
    s_nop 15
    s_waitcnt vmcnt(0) lgkmcnt(0)
    v_lshlrev_b32 v1, 4, v0
    v_mov_b32 v128, 0
    v_mov_b32 v129, 0
    v_mov_b32 v130, 0
    v_mov_b32 v131, 0
    v_mov_b32 v132, 0
    v_mov_b32 v133, 0
    v_mov_b32 v134, 0
    v_mov_b32 v135, 0
    v_mov_b32 v136, 0
    v_mov_b32 v137, 0
    v_mov_b32 v138, 0
    v_mov_b32 v139, 0
    v_mov_b32 v140, 0
    v_mov_b32 v141, 0
    v_mov_b32 v142, 0
    v_mov_b32 v143, 0
    v_mov_b32 v144, 0
    v_mov_b32 v145, 0
    v_mov_b32 v146, 0
    v_mov_b32 v147, 0
    v_mov_b32 v148, 0
    v_mov_b32 v149, 0
    v_mov_b32 v150, 0
    v_mov_b32 v151, 0
    v_mov_b32 v152, 0
    v_mov_b32 v153, 0
    v_mov_b32 v154, 0
    v_mov_b32 v155, 0
    v_mov_b32 v156, 0
    v_mov_b32 v157, 0
    v_mov_b32 v158, 0
    v_mov_b32 v159, 0
    v_mov_b32 v160, 0
    v_mov_b32 v161, 0
    v_mov_b32 v162, 0
    v_mov_b32 v163, 0
    v_mov_b32 v164, 0
    v_mov_b32 v165, 0
    v_mov_b32 v166, 0
    v_mov_b32 v167, 0
    v_mov_b32 v168, 0
    v_mov_b32 v169, 0
    v_mov_b32 v170, 0
    v_mov_b32 v171, 0
    v_mov_b32 v172, 0
    v_mov_b32 v173, 0
    v_mov_b32 v174, 0
    v_mov_b32 v175, 0
    v_mov_b32 v176, 0
    v_mov_b32 v177, 0
    v_mov_b32 v178, 0
    v_mov_b32 v179, 0
    v_mov_b32 v180, 0
    v_mov_b32 v181, 0
    v_mov_b32 v182, 0
    v_mov_b32 v183, 0
    v_mov_b32 v184, 0
    v_mov_b32 v185, 0
    v_mov_b32 v186, 0
    v_mov_b32 v187, 0
    v_mov_b32 v188, 0
    v_mov_b32 v189, 0
    v_mov_b32 v190, 0
    v_mov_b32 v191, 0
    v_mov_b32 v192, 0
    v_mov_b32 v193, 0
    v_mov_b32 v194, 0
    v_mov_b32 v195, 0
    v_mov_b32 v196, 0
    v_mov_b32 v197, 0
    v_mov_b32 v198, 0
    v_mov_b32 v199, 0
    v_mov_b32 v200, 0
    v_mov_b32 v201, 0
    v_mov_b32 v202, 0
    v_mov_b32 v203, 0
    v_mov_b32 v204, 0
    v_mov_b32 v205, 0
    v_mov_b32 v206, 0
    v_mov_b32 v207, 0
    v_mov_b32 v208, 0
    v_mov_b32 v209, 0
    v_mov_b32 v210, 0
    v_mov_b32 v211, 0
    v_mov_b32 v212, 0
    v_mov_b32 v213, 0
    v_mov_b32 v214, 0
    v_mov_b32 v215, 0
    v_mov_b32 v216, 0
    v_mov_b32 v217, 0
    v_mov_b32 v218, 0
    v_mov_b32 v219, 0
    v_mov_b32 v220, 0
    v_mov_b32 v221, 0
    v_mov_b32 v222, 0
    v_mov_b32 v223, 0
    v_mov_b32 v224, 0
    v_mov_b32 v225, 0
    v_mov_b32 v226, 0
    v_mov_b32 v227, 0
    v_mov_b32 v228, 0
    v_mov_b32 v229, 0
    v_mov_b32 v230, 0
    v_mov_b32 v231, 0
    v_mov_b32 v232, 0
    v_mov_b32 v233, 0
    v_mov_b32 v234, 0
    v_mov_b32 v235, 0
    v_mov_b32 v236, 0
    v_mov_b32 v237, 0
    v_mov_b32 v238, 0
    v_mov_b32 v239, 0
    v_mov_b32 v240, 0
    v_mov_b32 v241, 0
    v_mov_b32 v242, 0
    v_mov_b32 v243, 0
    v_mov_b32 v244, 0
    v_mov_b32 v245, 0
    v_mov_b32 v246, 0
    v_mov_b32 v247, 0
    v_mov_b32 v248, 0
    v_mov_b32 v249, 0
    v_mov_b32 v250, 0
    v_mov_b32 v251, 0
    v_mov_b32 v252, 0
    v_mov_b32 v253, 0
    v_mov_b32 v254, 0
    v_mov_b32 v255, 0
    v_mov_b32 v4, 0
    v_mov_b32 v5, 0
    v_mov_b32 v6, 0
    v_mov_b32 v7, 0
    v_mov_b32 v112, 0xff800000
    v_mov_b32 v113, 0xff800000
    v_mov_b32 v114, 0xff800000
    v_mov_b32 v115, 0xff800000
    s_mov_b32 s19, 0
M_safe_loop:
    s_add_u32 s52, s19, 62
    s_and_b32 s52, s52, 63
    s_lshl_b32 s52, s52, 14
    s_add_u32 s53, s52, 0x1000
    s_lshl_b32 s54, s19, 14
    s_add_u32 s54, s54, 0x2000
    s_add_u32 s55, s54, 0x1000
    buffer_load_dwordx4 a[136:139], v1, s[8:11], s52 offen offset:0 sc1
    buffer_load_dwordx4 a[140:143], v1, s[8:11], s52 offen offset:1024 sc1
    buffer_load_dwordx4 a[144:147], v1, s[8:11], s52 offen offset:2048 sc1
    buffer_load_dwordx4 a[148:151], v1, s[8:11], s52 offen offset:3072 sc1
    buffer_load_dwordx4 a[152:155], v1, s[8:11], s53 offen offset:0 sc1
    buffer_load_dwordx4 a[156:159], v1, s[8:11], s53 offen offset:1024 sc1
    buffer_load_dwordx4 a[160:163], v1, s[8:11], s53 offen offset:2048 sc1
    buffer_load_dwordx4 a[164:167], v1, s[8:11], s53 offen offset:3072 sc1
    buffer_load_dwordx4 a[168:171], v1, s[8:11], s54 offen offset:0 sc1
    buffer_load_dwordx4 a[172:175], v1, s[8:11], s54 offen offset:1024 sc1
    buffer_load_dwordx4 a[176:179], v1, s[8:11], s54 offen offset:2048 sc1
    buffer_load_dwordx4 a[180:183], v1, s[8:11], s54 offen offset:3072 sc1
    buffer_load_dwordx4 a[184:187], v1, s[8:11], s55 offen offset:0 sc1
    buffer_load_dwordx4 a[188:191], v1, s[8:11], s55 offen offset:1024 sc1
    buffer_load_dwordx4 a[192:195], v1, s[8:11], s55 offen offset:2048 sc1
    buffer_load_dwordx4 a[196:199], v1, s[8:11], s55 offen offset:3072 sc1
    s_waitcnt vmcnt(0)
    v_mfma_f32_16x16x32_bf16 v[16:19], a[136:139], a[0:3], 0
    v_mfma_f32_16x16x32_bf16 v[20:23], a[136:139], a[16:19], 0
    v_mfma_f32_16x16x32_bf16 v[24:27], a[136:139], a[32:35], 0
    v_mfma_f32_16x16x32_bf16 v[28:31], a[136:139], a[48:51], 0
    v_mfma_f32_16x16x32_bf16 v[16:19], a[140:143], a[4:7], v[16:19]
    v_mfma_f32_16x16x32_bf16 v[20:23], a[140:143], a[20:23], v[20:23]
    v_mfma_f32_16x16x32_bf16 v[24:27], a[140:143], a[36:39], v[24:27]
    v_mfma_f32_16x16x32_bf16 v[28:31], a[140:143], a[52:55], v[28:31]
    v_mfma_f32_16x16x32_bf16 v[16:19], a[144:147], a[8:11], v[16:19]
    v_mfma_f32_16x16x32_bf16 v[20:23], a[144:147], a[24:27], v[20:23]
    v_mfma_f32_16x16x32_bf16 v[24:27], a[144:147], a[40:43], v[24:27]
    v_mfma_f32_16x16x32_bf16 v[28:31], a[144:147], a[56:59], v[28:31]
    v_mfma_f32_16x16x32_bf16 v[16:19], a[148:151], a[12:15], v[16:19]
    v_mfma_f32_16x16x32_bf16 v[20:23], a[148:151], a[28:31], v[20:23]
    v_mfma_f32_16x16x32_bf16 v[24:27], a[148:151], a[44:47], v[24:27]
    v_mfma_f32_16x16x32_bf16 v[28:31], a[148:151], a[60:63], v[28:31]
    v_mfma_f32_16x16x32_bf16 v[32:35], a[152:155], a[0:3], 0
    v_mfma_f32_16x16x32_bf16 v[36:39], a[152:155], a[16:19], 0
    v_mfma_f32_16x16x32_bf16 v[40:43], a[152:155], a[32:35], 0
    v_mfma_f32_16x16x32_bf16 v[44:47], a[152:155], a[48:51], 0
    v_mfma_f32_16x16x32_bf16 v[32:35], a[156:159], a[4:7], v[32:35]
    v_mfma_f32_16x16x32_bf16 v[36:39], a[156:159], a[20:23], v[36:39]
    v_mfma_f32_16x16x32_bf16 v[40:43], a[156:159], a[36:39], v[40:43]
    v_mfma_f32_16x16x32_bf16 v[44:47], a[156:159], a[52:55], v[44:47]
    v_mfma_f32_16x16x32_bf16 v[32:35], a[160:163], a[8:11], v[32:35]
    v_mfma_f32_16x16x32_bf16 v[36:39], a[160:163], a[24:27], v[36:39]
    v_mfma_f32_16x16x32_bf16 v[40:43], a[160:163], a[40:43], v[40:43]
    v_mfma_f32_16x16x32_bf16 v[44:47], a[160:163], a[56:59], v[44:47]
    v_mfma_f32_16x16x32_bf16 v[32:35], a[164:167], a[12:15], v[32:35]
    v_mfma_f32_16x16x32_bf16 v[36:39], a[164:167], a[28:31], v[36:39]
    v_mfma_f32_16x16x32_bf16 v[40:43], a[164:167], a[44:47], v[40:43]
    v_mfma_f32_16x16x32_bf16 v[44:47], a[164:167], a[60:63], v[44:47]
    s_nop 15
    v_max3_f32 v8, v16, v17, v18
    v_max3_f32 v8, v8, v19, v32
    v_max3_f32 v8, v8, v33, v34
    v_max_f32 v8, v8, v35
    v_max3_f32 v9, v20, v21, v22
    v_max3_f32 v9, v9, v23, v36
    v_max3_f32 v9, v9, v37, v38
    v_max_f32 v9, v9, v39
    v_max3_f32 v10, v24, v25, v26
    v_max3_f32 v10, v10, v27, v40
    v_max3_f32 v10, v10, v41, v42
    v_max_f32 v10, v10, v43
    v_max3_f32 v11, v28, v29, v30
    v_max3_f32 v11, v11, v31, v44
    v_max3_f32 v11, v11, v45, v46
    v_max_f32 v11, v11, v47
    v_mov_b32 v12, v8
    v_mov_b32 v13, v9
    v_mov_b32 v14, v10
    v_mov_b32 v15, v11
    s_nop 1
    v_permlane32_swap_b32 v8, v12
    v_permlane32_swap_b32 v9, v13
    v_permlane32_swap_b32 v10, v14
    v_permlane32_swap_b32 v11, v15
    s_nop 1
    v_max_f32 v8, v8, v12
    v_max_f32 v9, v9, v13
    v_max_f32 v10, v10, v14
    v_max_f32 v11, v11, v15
    v_mov_b32 v12, v8
    v_mov_b32 v13, v9
    v_mov_b32 v14, v10
    v_mov_b32 v15, v11
    s_nop 1
    v_permlane16_swap_b32 v8, v12
    v_permlane16_swap_b32 v9, v13
    v_permlane16_swap_b32 v10, v14
    v_permlane16_swap_b32 v11, v15
    s_nop 1
    v_max_f32 v8, v8, v12
    v_max_f32 v9, v9, v13
    v_max_f32 v10, v10, v14
    v_max_f32 v11, v11, v15
    v_max_f32 v8, v8, v112
    v_max_f32 v9, v9, v113
    v_max_f32 v10, v10, v114
    v_max_f32 v11, v11, v115
    v_sub_f32 v116, v112, v8
    v_sub_f32 v117, v113, v9
    v_sub_f32 v118, v114, v10
    v_sub_f32 v119, v115, v11
    v_exp_f32 v116, v116
    v_exp_f32 v117, v117
    v_exp_f32 v118, v118
    v_exp_f32 v119, v119
    v_mov_b32 v112, v8
    v_mov_b32 v113, v9
    v_mov_b32 v114, v10
    v_mov_b32 v115, v11
    v_mul_f32 v4, v4, v116
    v_mul_f32 v5, v5, v117
    v_mul_f32 v6, v6, v118
    v_mul_f32 v7, v7, v119
    v_mul_f32 v128, v128, v116
    v_mul_f32 v129, v129, v116
    v_mul_f32 v130, v130, v116
    v_mul_f32 v131, v131, v116
    v_mul_f32 v132, v132, v117
    v_mul_f32 v133, v133, v117
    v_mul_f32 v134, v134, v117
    v_mul_f32 v135, v135, v117
    v_mul_f32 v136, v136, v118
    v_mul_f32 v137, v137, v118
    v_mul_f32 v138, v138, v118
    v_mul_f32 v139, v139, v118
    v_mul_f32 v140, v140, v119
    v_mul_f32 v141, v141, v119
    v_mul_f32 v142, v142, v119
    v_mul_f32 v143, v143, v119
    v_mul_f32 v144, v144, v116
    v_mul_f32 v145, v145, v116
    v_mul_f32 v146, v146, v116
    v_mul_f32 v147, v147, v116
    v_mul_f32 v148, v148, v117
    v_mul_f32 v149, v149, v117
    v_mul_f32 v150, v150, v117
    v_mul_f32 v151, v151, v117
    v_mul_f32 v152, v152, v118
    v_mul_f32 v153, v153, v118
    v_mul_f32 v154, v154, v118
    v_mul_f32 v155, v155, v118
    v_mul_f32 v156, v156, v119
    v_mul_f32 v157, v157, v119
    v_mul_f32 v158, v158, v119
    v_mul_f32 v159, v159, v119
    v_mul_f32 v160, v160, v116
    v_mul_f32 v161, v161, v116
    v_mul_f32 v162, v162, v116
    v_mul_f32 v163, v163, v116
    v_mul_f32 v164, v164, v117
    v_mul_f32 v165, v165, v117
    v_mul_f32 v166, v166, v117
    v_mul_f32 v167, v167, v117
    v_mul_f32 v168, v168, v118
    v_mul_f32 v169, v169, v118
    v_mul_f32 v170, v170, v118
    v_mul_f32 v171, v171, v118
    v_mul_f32 v172, v172, v119
    v_mul_f32 v173, v173, v119
    v_mul_f32 v174, v174, v119
    v_mul_f32 v175, v175, v119
    v_mul_f32 v176, v176, v116
    v_mul_f32 v177, v177, v116
    v_mul_f32 v178, v178, v116
    v_mul_f32 v179, v179, v116
    v_mul_f32 v180, v180, v117
    v_mul_f32 v181, v181, v117
    v_mul_f32 v182, v182, v117
    v_mul_f32 v183, v183, v117
    v_mul_f32 v184, v184, v118
    v_mul_f32 v185, v185, v118
    v_mul_f32 v186, v186, v118
    v_mul_f32 v187, v187, v118
    v_mul_f32 v188, v188, v119
    v_mul_f32 v189, v189, v119
    v_mul_f32 v190, v190, v119
    v_mul_f32 v191, v191, v119
    v_mul_f32 v192, v192, v116
    v_mul_f32 v193, v193, v116
    v_mul_f32 v194, v194, v116
    v_mul_f32 v195, v195, v116
    v_mul_f32 v196, v196, v117
    v_mul_f32 v197, v197, v117
    v_mul_f32 v198, v198, v117
    v_mul_f32 v199, v199, v117
    v_mul_f32 v200, v200, v118
    v_mul_f32 v201, v201, v118
    v_mul_f32 v202, v202, v118
    v_mul_f32 v203, v203, v118
    v_mul_f32 v204, v204, v119
    v_mul_f32 v205, v205, v119
    v_mul_f32 v206, v206, v119
    v_mul_f32 v207, v207, v119
    v_mul_f32 v208, v208, v116
    v_mul_f32 v209, v209, v116
    v_mul_f32 v210, v210, v116
    v_mul_f32 v211, v211, v116
    v_mul_f32 v212, v212, v117
    v_mul_f32 v213, v213, v117
    v_mul_f32 v214, v214, v117
    v_mul_f32 v215, v215, v117
    v_mul_f32 v216, v216, v118
    v_mul_f32 v217, v217, v118
    v_mul_f32 v218, v218, v118
    v_mul_f32 v219, v219, v118
    v_mul_f32 v220, v220, v119
    v_mul_f32 v221, v221, v119
    v_mul_f32 v222, v222, v119
    v_mul_f32 v223, v223, v119
    v_mul_f32 v224, v224, v116
    v_mul_f32 v225, v225, v116
    v_mul_f32 v226, v226, v116
    v_mul_f32 v227, v227, v116
    v_mul_f32 v228, v228, v117
    v_mul_f32 v229, v229, v117
    v_mul_f32 v230, v230, v117
    v_mul_f32 v231, v231, v117
    v_mul_f32 v232, v232, v118
    v_mul_f32 v233, v233, v118
    v_mul_f32 v234, v234, v118
    v_mul_f32 v235, v235, v118
    v_mul_f32 v236, v236, v119
    v_mul_f32 v237, v237, v119
    v_mul_f32 v238, v238, v119
    v_mul_f32 v239, v239, v119
    v_mul_f32 v240, v240, v116
    v_mul_f32 v241, v241, v116
    v_mul_f32 v242, v242, v116
    v_mul_f32 v243, v243, v116
    v_mul_f32 v244, v244, v117
    v_mul_f32 v245, v245, v117
    v_mul_f32 v246, v246, v117
    v_mul_f32 v247, v247, v117
    v_mul_f32 v248, v248, v118
    v_mul_f32 v249, v249, v118
    v_mul_f32 v250, v250, v118
    v_mul_f32 v251, v251, v118
    v_mul_f32 v252, v252, v119
    v_mul_f32 v253, v253, v119
    v_mul_f32 v254, v254, v119
    v_mul_f32 v255, v255, v119
    v_sub_f32 v16, v16, v112
    v_sub_f32 v17, v17, v112
    v_sub_f32 v18, v18, v112
    v_sub_f32 v19, v19, v112
    v_sub_f32 v20, v20, v113
    v_sub_f32 v21, v21, v113
    v_sub_f32 v22, v22, v113
    v_sub_f32 v23, v23, v113
    v_sub_f32 v24, v24, v114
    v_sub_f32 v25, v25, v114
    v_sub_f32 v26, v26, v114
    v_sub_f32 v27, v27, v114
    v_sub_f32 v28, v28, v115
    v_sub_f32 v29, v29, v115
    v_sub_f32 v30, v30, v115
    v_sub_f32 v31, v31, v115
    v_sub_f32 v32, v32, v112
    v_sub_f32 v33, v33, v112
    v_sub_f32 v34, v34, v112
    v_sub_f32 v35, v35, v112
    v_sub_f32 v36, v36, v113
    v_sub_f32 v37, v37, v113
    v_sub_f32 v38, v38, v113
    v_sub_f32 v39, v39, v113
    v_sub_f32 v40, v40, v114
    v_sub_f32 v41, v41, v114
    v_sub_f32 v42, v42, v114
    v_sub_f32 v43, v43, v114
    v_sub_f32 v44, v44, v115
    v_sub_f32 v45, v45, v115
    v_sub_f32 v46, v46, v115
    v_sub_f32 v47, v47, v115
    v_exp_f32 v16, v16
    v_exp_f32 v17, v17
    v_exp_f32 v18, v18
    v_exp_f32 v19, v19
    v_exp_f32 v20, v20
    v_exp_f32 v21, v21
    v_exp_f32 v22, v22
    v_exp_f32 v23, v23
    v_exp_f32 v24, v24
    v_exp_f32 v25, v25
    v_exp_f32 v26, v26
    v_exp_f32 v27, v27
    v_exp_f32 v28, v28
    v_exp_f32 v29, v29
    v_exp_f32 v30, v30
    v_exp_f32 v31, v31
    v_exp_f32 v32, v32
    v_exp_f32 v33, v33
    v_exp_f32 v34, v34
    v_exp_f32 v35, v35
    v_exp_f32 v36, v36
    v_exp_f32 v37, v37
    v_exp_f32 v38, v38
    v_exp_f32 v39, v39
    v_exp_f32 v40, v40
    v_exp_f32 v41, v41
    v_exp_f32 v42, v42
    v_exp_f32 v43, v43
    v_exp_f32 v44, v44
    v_exp_f32 v45, v45
    v_exp_f32 v46, v46
    v_exp_f32 v47, v47
    s_nop 0
    v_add_f32 v4, v4, v16
    v_add_f32 v4, v4, v17
    v_add_f32 v4, v4, v18
    v_add_f32 v4, v4, v19
    v_add_f32 v5, v5, v20
    v_add_f32 v5, v5, v21
    v_add_f32 v5, v5, v22
    v_add_f32 v5, v5, v23
    v_add_f32 v6, v6, v24
    v_add_f32 v6, v6, v25
    v_add_f32 v6, v6, v26
    v_add_f32 v6, v6, v27
    v_add_f32 v7, v7, v28
    v_add_f32 v7, v7, v29
    v_add_f32 v7, v7, v30
    v_add_f32 v7, v7, v31
    v_add_f32 v4, v4, v32
    v_add_f32 v4, v4, v33
    v_add_f32 v4, v4, v34
    v_add_f32 v4, v4, v35
    v_add_f32 v5, v5, v36
    v_add_f32 v5, v5, v37
    v_add_f32 v5, v5, v38
    v_add_f32 v5, v5, v39
    v_add_f32 v6, v6, v40
    v_add_f32 v6, v6, v41
    v_add_f32 v6, v6, v42
    v_add_f32 v6, v6, v43
    v_add_f32 v7, v7, v44
    v_add_f32 v7, v7, v45
    v_add_f32 v7, v7, v46
    v_add_f32 v7, v7, v47
    v_cvt_pk_bf16_f32 v80, v16, v17
    v_cvt_pk_bf16_f32 v81, v18, v19
    v_cvt_pk_bf16_f32 v84, v20, v21
    v_cvt_pk_bf16_f32 v85, v22, v23
    v_cvt_pk_bf16_f32 v88, v24, v25
    v_cvt_pk_bf16_f32 v89, v26, v27
    v_cvt_pk_bf16_f32 v92, v28, v29
    v_cvt_pk_bf16_f32 v93, v30, v31
    v_cvt_pk_bf16_f32 v82, v32, v33
    v_cvt_pk_bf16_f32 v83, v34, v35
    v_cvt_pk_bf16_f32 v86, v36, v37
    v_cvt_pk_bf16_f32 v87, v38, v39
    v_cvt_pk_bf16_f32 v90, v40, v41
    v_cvt_pk_bf16_f32 v91, v42, v43
    v_cvt_pk_bf16_f32 v94, v44, v45
    v_cvt_pk_bf16_f32 v95, v46, v47
    s_nop 1
    v_mfma_f32_16x16x32_bf16 v[128:131], a[168:171], v[80:83], v[128:131]
    v_mfma_f32_16x16x32_bf16 v[132:135], a[168:171], v[84:87], v[132:135]
    v_mfma_f32_16x16x32_bf16 v[136:139], a[168:171], v[88:91], v[136:139]
    v_mfma_f32_16x16x32_bf16 v[140:143], a[168:171], v[92:95], v[140:143]
    v_mfma_f32_16x16x32_bf16 v[144:147], a[172:175], v[80:83], v[144:147]
    v_mfma_f32_16x16x32_bf16 v[148:151], a[172:175], v[84:87], v[148:151]
    v_mfma_f32_16x16x32_bf16 v[152:155], a[172:175], v[88:91], v[152:155]
    v_mfma_f32_16x16x32_bf16 v[156:159], a[172:175], v[92:95], v[156:159]
    v_mfma_f32_16x16x32_bf16 v[160:163], a[176:179], v[80:83], v[160:163]
    v_mfma_f32_16x16x32_bf16 v[164:167], a[176:179], v[84:87], v[164:167]
    v_mfma_f32_16x16x32_bf16 v[168:171], a[176:179], v[88:91], v[168:171]
    v_mfma_f32_16x16x32_bf16 v[172:175], a[176:179], v[92:95], v[172:175]
    v_mfma_f32_16x16x32_bf16 v[176:179], a[180:183], v[80:83], v[176:179]
    v_mfma_f32_16x16x32_bf16 v[180:183], a[180:183], v[84:87], v[180:183]
    v_mfma_f32_16x16x32_bf16 v[184:187], a[180:183], v[88:91], v[184:187]
    v_mfma_f32_16x16x32_bf16 v[188:191], a[180:183], v[92:95], v[188:191]
    v_mfma_f32_16x16x32_bf16 v[192:195], a[184:187], v[80:83], v[192:195]
    v_mfma_f32_16x16x32_bf16 v[196:199], a[184:187], v[84:87], v[196:199]
    v_mfma_f32_16x16x32_bf16 v[200:203], a[184:187], v[88:91], v[200:203]
    v_mfma_f32_16x16x32_bf16 v[204:207], a[184:187], v[92:95], v[204:207]
    v_mfma_f32_16x16x32_bf16 v[208:211], a[188:191], v[80:83], v[208:211]
    v_mfma_f32_16x16x32_bf16 v[212:215], a[188:191], v[84:87], v[212:215]
    v_mfma_f32_16x16x32_bf16 v[216:219], a[188:191], v[88:91], v[216:219]
    v_mfma_f32_16x16x32_bf16 v[220:223], a[188:191], v[92:95], v[220:223]
    v_mfma_f32_16x16x32_bf16 v[224:227], a[192:195], v[80:83], v[224:227]
    v_mfma_f32_16x16x32_bf16 v[228:231], a[192:195], v[84:87], v[228:231]
    v_mfma_f32_16x16x32_bf16 v[232:235], a[192:195], v[88:91], v[232:235]
    v_mfma_f32_16x16x32_bf16 v[236:239], a[192:195], v[92:95], v[236:239]
    v_mfma_f32_16x16x32_bf16 v[240:243], a[196:199], v[80:83], v[240:243]
    v_mfma_f32_16x16x32_bf16 v[244:247], a[196:199], v[84:87], v[244:247]
    v_mfma_f32_16x16x32_bf16 v[248:251], a[196:199], v[88:91], v[248:251]
    v_mfma_f32_16x16x32_bf16 v[252:255], a[196:199], v[92:95], v[252:255]
    s_nop 15
    s_add_u32 s19, s19, 1
    s_cmp_lt_u32 s19, 64
    s_cbranch_scc1 M_safe_loop
    v_mov_b32 v8, v4
    v_mov_b32 v9, v5
    v_mov_b32 v10, v6
    v_mov_b32 v11, v7
    s_nop 1
    v_permlane32_swap_b32 v4, v8
    v_permlane32_swap_b32 v5, v9
    v_permlane32_swap_b32 v6, v10
    v_permlane32_swap_b32 v7, v11
    s_nop 1
    v_add_f32 v4, v4, v8
    v_add_f32 v5, v5, v9
    v_add_f32 v6, v6, v10
    v_add_f32 v7, v7, v11
    v_mov_b32 v8, v4
    v_mov_b32 v9, v5
    v_mov_b32 v10, v6
    v_mov_b32 v11, v7
    s_nop 1
    v_permlane16_swap_b32 v4, v8
    v_permlane16_swap_b32 v5, v9
    v_permlane16_swap_b32 v6, v10
    v_permlane16_swap_b32 v7, v11
    s_nop 1
    v_add_f32 v4, v4, v8
    v_add_f32 v5, v5, v9
    v_add_f32 v6, v6, v10
    v_add_f32 v7, v7, v11
    s_branch M_fin
.section .rodata,"a"
.p2align 6
.amdhsa_kernel standalone__kv_cache_quant_int4_int2_kv_with_per_channel_or_per_token_scales__prompt_kernel
  .amdhsa_next_free_vgpr 456
  .amdhsa_next_free_sgpr 102
  .amdhsa_accum_offset 256
  .amdhsa_group_segment_fixed_size 0
  .amdhsa_kernarg_size 80
  .amdhsa_user_sgpr_count 2
  .amdhsa_user_sgpr_kernarg_segment_ptr 1
  .amdhsa_system_sgpr_workgroup_id_x 1
  .amdhsa_float_denorm_mode_32 3
.end_amdhsa_kernel
```
